```python
import torch

def _softmax(x, axis=-1):
    return torch.softmax(x, dim=axis)
def _gelu(x):
    return torch.nn.functional.gelu(x, approximate="tanh")
def _silu(x):
    return torch.nn.functional.silu(x)
def _sigmoid(x):
    return torch.sigmoid(x)
def _layernorm(x, axis=-1, eps=1e-5):
    m = x.mean(dim=axis, keepdim=True)
    v = x.var(dim=axis, keepdim=True, unbiased=False)
    return (x - m) / torch.sqrt(v + eps)
def _scatter_add(tgt, idx, src, axis=0):
    return tgt.clone().index_add_(axis, idx, src)
def _segment_sum(src, seg, n):
    out = torch.zeros((n,) + src.shape[1:], dtype=src.dtype)
    return out.index_add_(0, seg, src)
def _pad(x, pw):
    flat = tuple(v for pair in reversed(pw) for v in pair)
    return torch.nn.functional.pad(x, flat)

kernel_name = 'interleave_layers__linear_attn_block__mixer_channel_mlp__prompt'

def setup_inputs():

    _w = (lambda a: (lambda t: t.to(torch.bfloat16) if t.is_floating_point() else t)(torch.as_tensor(a)))
    def _A_setup():
        B, S, D = 1, 2048, 1024
        return {
            "x": _w((lambda *s: torch.randn(*s, dtype=torch.bfloat16) * 0.05)(B, S, D)),
            "wqkv": _w((lambda *s: torch.randn(*s, dtype=torch.bfloat16) * 0.05)(D, 3 * D)),
            "wo": _w((lambda *s: torch.randn(*s, dtype=torch.bfloat16) * 0.05)(D, D)),
        }
    _A_in = _A_setup()

    def _B_setup():
        B, S, D, F = 1, 2048, 1024, 3584
        return {
            "x": _w((lambda *s: torch.randn(*s, dtype=torch.bfloat16) * 0.05)(B, S, D)),
            "w1": _w((lambda *s: torch.randn(*s, dtype=torch.bfloat16) * 3.2)(D, F) * (D ** -0.5)),
            "b1": _w((lambda *s: torch.randn(*s, dtype=torch.bfloat16) * 0.4)(F)),
            "w2": _w((lambda *s: torch.randn(*s, dtype=torch.bfloat16) * 0.4)(F, D) * (F ** -0.5)),
            "b2": _w((lambda *s: torch.randn(*s, dtype=torch.bfloat16) * 0.4)(D)),
        }
    _B_in = _B_setup()

    return {
        "A_x": _A_in["x"],
        "A_wqkv": _A_in["wqkv"],
        "A_wo": _A_in["wo"],
        "B_x": _B_in["x"],
        "B_w1": _B_in["w1"],
        "B_b1": _B_in["b1"],
        "B_w2": _B_in["w2"],
        "B_b2": _B_in["b2"],
    }

def reference(A_x, A_wqkv, A_wo, B_x, B_w1, B_b1, B_w2, B_b2):
    def _A_ref(x, wqkv, wo):
        B, S, D = x.shape
        H = 32; Dh = D // H
        qkv = (lambda x, *d: x.permute(*d))((x @ wqkv).reshape(B, S, 3, H, Dh), 2, 0, 3, 1, 4)
        q, k, v = qkv[0], qkv[1], qkv[2]
        phi = lambda t: torch.where(t > 0, t + 1, torch.exp(t)) + 1e-6
        pq, pk = phi(q), phi(k)
        kv = torch.einsum("bhsd,bhse->bhde", pk, v)
        z = torch.einsum("bhsd->bhd", pk)
        num = torch.einsum("bhqd,bhde->bhqe", pq, kv)
        den = torch.einsum("bhqd,bhd->bhq", pq, z)[..., None] + 1e-6
        o = num / den
        return (lambda x, *d: x.permute(*d))(o, 0, 2, 1, 3).reshape(B, S, D) @ wo

    def _B_ref(x, w1, b1, w2, b2):
        y = _layernorm(x, axis=-1)
        h = _gelu(torch.einsum("bsd,df->bsf", y, w1) + b1)
        return torch.einsum("bsf,fd->bsd", h, w2) + b2

    x = A_x
    x = x + _A_ref(_layernorm(x, axis=-1), A_wqkv, A_wo)
    x = x + _B_ref(_layernorm(x, axis=-1), B_w1, B_b1, B_w2, B_b2)
    x = x + _A_ref(_layernorm(x, axis=-1), A_wqkv, A_wo)
    x = x + _B_ref(_layernorm(x, axis=-1), B_w1, B_b1, B_w2, B_b2)
    return x
```

```asm
; @launch kernel=ln_in_kernel grid=(512,1,1) block=(256,1,1) lds=0
; @launch kernel=gemm_qkv_kernel grid=(256,1,1) block=(512,1,1) lds=122880
; @launch kernel=attn_o_kernel grid=(256,1,1) block=(256,1,1) lds=4096
; @launch kernel=gemm_wo_kernel grid=(256,1,1) block=(512,1,1) lds=73728
; @launch kernel=ln_two_kernel grid=(512,1,1) block=(256,1,1) lds=0
; @launch kernel=gemm_w1_kernel grid=(256,1,1) block=(512,1,1) lds=147456
; @launch kernel=gemm_w2_kernel grid=(256,1,1) block=(512,1,1) lds=98304
; @launch kernel=ln_red_kernel grid=(512,1,1) block=(256,1,1) lds=0
; @launch kernel=gemm_qkv_kernel grid=(256,1,1) block=(512,1,1) lds=122880
; @launch kernel=attn_o_kernel grid=(256,1,1) block=(256,1,1) lds=4096
; @launch kernel=gemm_wo_kernel grid=(256,1,1) block=(512,1,1) lds=73728
; @launch kernel=ln_two_kernel grid=(512,1,1) block=(256,1,1) lds=0
; @launch kernel=gemm_w1_kernel grid=(256,1,1) block=(512,1,1) lds=147456
; @launch kernel=gemm_w2_kernel grid=(256,1,1) block=(512,1,1) lds=98304
; @launch kernel=ln_out_kernel grid=(512,1,1) block=(256,1,1) lds=0
.amdgcn_target "amdgcn-amd-amdhsa--gfx950"
.text
.globl ln_in_kernel
.p2align 8
.type ln_in_kernel,@function
ln_in_kernel:
    s_cmp_ge_u32 s2, 512
    s_cbranch_scc1 L_ln_in_kernel_end
    s_load_dwordx2 s[4:5], s[0:1], 80
    s_load_dwordx2 s[6:7], s[0:1], 0
    v_and_b32 v1, 63, v0
    v_lshrrev_b32 v2, 6, v0
    s_lshl_b32 s3, s2, 2
    v_add_u32 v2, s3, v2
    v_lshlrev_b32 v3, 11, v2
    v_lshl_add_u32 v3, v1, 4, v3
    v_lshlrev_b32 v4, 12, v2
    v_lshl_add_u32 v4, v1, 5, v4
    v_lshlrev_b32 v5, 4, v1
    s_waitcnt lgkmcnt(0)
    s_add_u32 s12, s4, 0
    s_addc_u32 s13, s5, 0
    s_mov_b32 s14, 4194304
    s_mov_b32 s15, 0x00020000
    s_add_u32 s16, s4, 4194304
    s_addc_u32 s17, s5, 0
    s_mov_b32 s18, 4194304
    s_mov_b32 s19, 0x00020000
    s_add_u32 s20, s6, 0
    s_addc_u32 s21, s7, 0
    s_mov_b32 s22, 4194304
    s_mov_b32 s23, 0x00020000
    buffer_load_dwordx4 v[8:11], v3, s[20:23], 0 offen
    buffer_load_dwordx4 v[12:15], v3, s[20:23], 0 offen offset:1024
    s_waitcnt vmcnt(0)
    v_lshlrev_b32 v16, 16, v8
    v_and_b32 v17, 0xffff0000, v8
    v_lshlrev_b32 v18, 16, v9
    v_and_b32 v19, 0xffff0000, v9
    v_lshlrev_b32 v20, 16, v10
    v_and_b32 v21, 0xffff0000, v10
    v_lshlrev_b32 v22, 16, v11
    v_and_b32 v23, 0xffff0000, v11
    v_lshlrev_b32 v24, 16, v12
    v_and_b32 v25, 0xffff0000, v12
    v_lshlrev_b32 v26, 16, v13
    v_and_b32 v27, 0xffff0000, v13
    v_lshlrev_b32 v28, 16, v14
    v_and_b32 v29, 0xffff0000, v14
    v_lshlrev_b32 v30, 16, v15
    v_and_b32 v31, 0xffff0000, v15
    buffer_store_dwordx4 v[8:11], v3, s[12:15], 0 offen
    buffer_store_dwordx4 v[12:15], v3, s[12:15], 0 offen offset:1024
    v_add_f32 v6, v16, v17
    v_add_f32 v6, v6, v18
    v_add_f32 v6, v6, v19
    v_add_f32 v6, v6, v20
    v_add_f32 v6, v6, v21
    v_add_f32 v6, v6, v22
    v_add_f32 v6, v6, v23
    v_add_f32 v6, v6, v24
    v_add_f32 v6, v6, v25
    v_add_f32 v6, v6, v26
    v_add_f32 v6, v6, v27
    v_add_f32 v6, v6, v28
    v_add_f32 v6, v6, v29
    v_add_f32 v6, v6, v30
    v_add_f32 v6, v6, v31
    ds_swizzle_b32 v7, v6 offset:1055
    s_waitcnt lgkmcnt(0)
    v_add_f32 v6, v6, v7
    ds_swizzle_b32 v7, v6 offset:2079
    s_waitcnt lgkmcnt(0)
    v_add_f32 v6, v6, v7
    ds_swizzle_b32 v7, v6 offset:4127
    s_waitcnt lgkmcnt(0)
    v_add_f32 v6, v6, v7
    ds_swizzle_b32 v7, v6 offset:8223
    s_waitcnt lgkmcnt(0)
    v_add_f32 v6, v6, v7
    ds_swizzle_b32 v7, v6 offset:16415
    s_waitcnt lgkmcnt(0)
    v_add_f32 v6, v6, v7
    s_nop 1
    v_readlane_b32 s40, v6, 0
    v_readlane_b32 s41, v6, 32
    s_nop 3
    v_mov_b32 v7, s41
    v_add_f32 v6, s40, v7
    v_mul_f32 v6, 0x3a800000, v6
    v_sub_f32 v16, v16, v6
    v_sub_f32 v17, v17, v6
    v_sub_f32 v18, v18, v6
    v_sub_f32 v19, v19, v6
    v_sub_f32 v20, v20, v6
    v_sub_f32 v21, v21, v6
    v_sub_f32 v22, v22, v6
    v_sub_f32 v23, v23, v6
    v_sub_f32 v24, v24, v6
    v_sub_f32 v25, v25, v6
    v_sub_f32 v26, v26, v6
    v_sub_f32 v27, v27, v6
    v_sub_f32 v28, v28, v6
    v_sub_f32 v29, v29, v6
    v_sub_f32 v30, v30, v6
    v_sub_f32 v31, v31, v6
    v_mul_f32 v6, v16, v16
    v_fmac_f32 v6, v17, v17
    v_fmac_f32 v6, v18, v18
    v_fmac_f32 v6, v19, v19
    v_fmac_f32 v6, v20, v20
    v_fmac_f32 v6, v21, v21
    v_fmac_f32 v6, v22, v22
    v_fmac_f32 v6, v23, v23
    v_fmac_f32 v6, v24, v24
    v_fmac_f32 v6, v25, v25
    v_fmac_f32 v6, v26, v26
    v_fmac_f32 v6, v27, v27
    v_fmac_f32 v6, v28, v28
    v_fmac_f32 v6, v29, v29
    v_fmac_f32 v6, v30, v30
    v_fmac_f32 v6, v31, v31
    ds_swizzle_b32 v7, v6 offset:1055
    s_waitcnt lgkmcnt(0)
    v_add_f32 v6, v6, v7
    ds_swizzle_b32 v7, v6 offset:2079
    s_waitcnt lgkmcnt(0)
    v_add_f32 v6, v6, v7
    ds_swizzle_b32 v7, v6 offset:4127
    s_waitcnt lgkmcnt(0)
    v_add_f32 v6, v6, v7
    ds_swizzle_b32 v7, v6 offset:8223
    s_waitcnt lgkmcnt(0)
    v_add_f32 v6, v6, v7
    ds_swizzle_b32 v7, v6 offset:16415
    s_waitcnt lgkmcnt(0)
    v_add_f32 v6, v6, v7
    s_nop 1
    v_readlane_b32 s40, v6, 0
    v_readlane_b32 s41, v6, 32
    s_nop 3
    v_mov_b32 v7, s41
    v_add_f32 v6, s40, v7
    v_mov_b32 v7, 0x3727c5ac
    v_fmac_f32 v7, 0x3a800000, v6
    v_rsq_f32 v7, v7
    s_nop 1
    v_mul_f32 v16, v16, v7
    v_mul_f32 v17, v17, v7
    v_mul_f32 v18, v18, v7
    v_mul_f32 v19, v19, v7
    v_mul_f32 v20, v20, v7
    v_mul_f32 v21, v21, v7
    v_mul_f32 v22, v22, v7
    v_mul_f32 v23, v23, v7
    v_mul_f32 v24, v24, v7
    v_mul_f32 v25, v25, v7
    v_mul_f32 v26, v26, v7
    v_mul_f32 v27, v27, v7
    v_mul_f32 v28, v28, v7
    v_mul_f32 v29, v29, v7
    v_mul_f32 v30, v30, v7
    v_mul_f32 v31, v31, v7
    s_nop 1
    v_cvt_pk_bf16_f32 v32, v16, v17
    v_cvt_pk_bf16_f32 v33, v18, v19
    v_cvt_pk_bf16_f32 v34, v20, v21
    v_cvt_pk_bf16_f32 v35, v22, v23
    v_cvt_pk_bf16_f32 v36, v24, v25
    v_cvt_pk_bf16_f32 v37, v26, v27
    v_cvt_pk_bf16_f32 v38, v28, v29
    v_cvt_pk_bf16_f32 v39, v30, v31
    s_nop 1
    buffer_store_dwordx4 v[32:35], v3, s[16:19], 0 offen
    buffer_store_dwordx4 v[36:39], v3, s[16:19], 0 offen offset:1024
L_ln_in_kernel_end:
    s_endpgm
.globl ln_two_kernel
.p2align 8
.type ln_two_kernel,@function
ln_two_kernel:
    s_cmp_ge_u32 s2, 512
    s_cbranch_scc1 L_ln_two_kernel_end
    s_load_dwordx2 s[4:5], s[0:1], 80
    v_and_b32 v1, 63, v0
    v_lshrrev_b32 v2, 6, v0
    s_lshl_b32 s3, s2, 2
    v_add_u32 v2, s3, v2
    v_lshlrev_b32 v3, 11, v2
    v_lshl_add_u32 v3, v1, 4, v3
    v_lshlrev_b32 v4, 12, v2
    v_lshl_add_u32 v4, v1, 5, v4
    v_lshlrev_b32 v5, 4, v1
    s_waitcnt lgkmcnt(0)
    s_add_u32 s12, s4, 0
    s_addc_u32 s13, s5, 0
    s_mov_b32 s14, 4194304
    s_mov_b32 s15, 0x00020000
    s_add_u32 s16, s4, 4194304
    s_addc_u32 s17, s5, 0
    s_mov_b32 s18, 4194304
    s_mov_b32 s19, 0x00020000
    buffer_load_dwordx4 v[8:11], v3, s[12:15], 0 offen
    buffer_load_dwordx4 v[12:15], v3, s[12:15], 0 offen offset:1024
    s_waitcnt vmcnt(0)
    v_lshlrev_b32 v16, 16, v8
    v_and_b32 v17, 0xffff0000, v8
    v_lshlrev_b32 v18, 16, v9
    v_and_b32 v19, 0xffff0000, v9
    v_lshlrev_b32 v20, 16, v10
    v_and_b32 v21, 0xffff0000, v10
    v_lshlrev_b32 v22, 16, v11
    v_and_b32 v23, 0xffff0000, v11
    v_lshlrev_b32 v24, 16, v12
    v_and_b32 v25, 0xffff0000, v12
    v_lshlrev_b32 v26, 16, v13
    v_and_b32 v27, 0xffff0000, v13
    v_lshlrev_b32 v28, 16, v14
    v_and_b32 v29, 0xffff0000, v14
    v_lshlrev_b32 v30, 16, v15
    v_and_b32 v31, 0xffff0000, v15
    v_add_f32 v6, v16, v17
    v_add_f32 v6, v6, v18
    v_add_f32 v6, v6, v19
    v_add_f32 v6, v6, v20
    v_add_f32 v6, v6, v21
    v_add_f32 v6, v6, v22
    v_add_f32 v6, v6, v23
    v_add_f32 v6, v6, v24
    v_add_f32 v6, v6, v25
    v_add_f32 v6, v6, v26
    v_add_f32 v6, v6, v27
    v_add_f32 v6, v6, v28
    v_add_f32 v6, v6, v29
    v_add_f32 v6, v6, v30
    v_add_f32 v6, v6, v31
    ds_swizzle_b32 v7, v6 offset:1055
    s_waitcnt lgkmcnt(0)
    v_add_f32 v6, v6, v7
    ds_swizzle_b32 v7, v6 offset:2079
    s_waitcnt lgkmcnt(0)
    v_add_f32 v6, v6, v7
    ds_swizzle_b32 v7, v6 offset:4127
    s_waitcnt lgkmcnt(0)
    v_add_f32 v6, v6, v7
    ds_swizzle_b32 v7, v6 offset:8223
    s_waitcnt lgkmcnt(0)
    v_add_f32 v6, v6, v7
    ds_swizzle_b32 v7, v6 offset:16415
    s_waitcnt lgkmcnt(0)
    v_add_f32 v6, v6, v7
    s_nop 1
    v_readlane_b32 s40, v6, 0
    v_readlane_b32 s41, v6, 32
    s_nop 3
    v_mov_b32 v7, s41
    v_add_f32 v6, s40, v7
    v_mul_f32 v6, 0x3a800000, v6
    v_sub_f32 v16, v16, v6
    v_sub_f32 v17, v17, v6
    v_sub_f32 v18, v18, v6
    v_sub_f32 v19, v19, v6
    v_sub_f32 v20, v20, v6
    v_sub_f32 v21, v21, v6
    v_sub_f32 v22, v22, v6
    v_sub_f32 v23, v23, v6
    v_sub_f32 v24, v24, v6
    v_sub_f32 v25, v25, v6
    v_sub_f32 v26, v26, v6
    v_sub_f32 v27, v27, v6
    v_sub_f32 v28, v28, v6
    v_sub_f32 v29, v29, v6
    v_sub_f32 v30, v30, v6
    v_sub_f32 v31, v31, v6
    v_mul_f32 v6, v16, v16
    v_fmac_f32 v6, v17, v17
    v_fmac_f32 v6, v18, v18
    v_fmac_f32 v6, v19, v19
    v_fmac_f32 v6, v20, v20
    v_fmac_f32 v6, v21, v21
    v_fmac_f32 v6, v22, v22
    v_fmac_f32 v6, v23, v23
    v_fmac_f32 v6, v24, v24
    v_fmac_f32 v6, v25, v25
    v_fmac_f32 v6, v26, v26
    v_fmac_f32 v6, v27, v27
    v_fmac_f32 v6, v28, v28
    v_fmac_f32 v6, v29, v29
    v_fmac_f32 v6, v30, v30
    v_fmac_f32 v6, v31, v31
    ds_swizzle_b32 v7, v6 offset:1055
    s_waitcnt lgkmcnt(0)
    v_add_f32 v6, v6, v7
    ds_swizzle_b32 v7, v6 offset:2079
    s_waitcnt lgkmcnt(0)
    v_add_f32 v6, v6, v7
    ds_swizzle_b32 v7, v6 offset:4127
    s_waitcnt lgkmcnt(0)
    v_add_f32 v6, v6, v7
    ds_swizzle_b32 v7, v6 offset:8223
    s_waitcnt lgkmcnt(0)
    v_add_f32 v6, v6, v7
    ds_swizzle_b32 v7, v6 offset:16415
    s_waitcnt lgkmcnt(0)
    v_add_f32 v6, v6, v7
    s_nop 1
    v_readlane_b32 s40, v6, 0
    v_readlane_b32 s41, v6, 32
    s_nop 3
    v_mov_b32 v7, s41
    v_add_f32 v6, s40, v7
    v_mov_b32 v7, 0x3727c5ac
    v_fmac_f32 v7, 0x3a800000, v6
    v_rsq_f32 v7, v7
    s_nop 1
    v_mul_f32 v16, v16, v7
    v_mul_f32 v17, v17, v7
    v_mul_f32 v18, v18, v7
    v_mul_f32 v19, v19, v7
    v_mul_f32 v20, v20, v7
    v_mul_f32 v21, v21, v7
    v_mul_f32 v22, v22, v7
    v_mul_f32 v23, v23, v7
    v_mul_f32 v24, v24, v7
    v_mul_f32 v25, v25, v7
    v_mul_f32 v26, v26, v7
    v_mul_f32 v27, v27, v7
    v_mul_f32 v28, v28, v7
    v_mul_f32 v29, v29, v7
    v_mul_f32 v30, v30, v7
    v_mul_f32 v31, v31, v7
    v_cvt_pk_bf16_f32 v8, v16, v17
    v_cvt_pk_bf16_f32 v9, v18, v19
    v_cvt_pk_bf16_f32 v10, v20, v21
    v_cvt_pk_bf16_f32 v11, v22, v23
    v_cvt_pk_bf16_f32 v12, v24, v25
    v_cvt_pk_bf16_f32 v13, v26, v27
    v_cvt_pk_bf16_f32 v14, v28, v29
    v_cvt_pk_bf16_f32 v15, v30, v31
    v_lshlrev_b32 v16, 16, v8
    v_and_b32 v17, 0xffff0000, v8
    v_lshlrev_b32 v18, 16, v9
    v_and_b32 v19, 0xffff0000, v9
    v_lshlrev_b32 v20, 16, v10
    v_and_b32 v21, 0xffff0000, v10
    v_lshlrev_b32 v22, 16, v11
    v_and_b32 v23, 0xffff0000, v11
    v_lshlrev_b32 v24, 16, v12
    v_and_b32 v25, 0xffff0000, v12
    v_lshlrev_b32 v26, 16, v13
    v_and_b32 v27, 0xffff0000, v13
    v_lshlrev_b32 v28, 16, v14
    v_and_b32 v29, 0xffff0000, v14
    v_lshlrev_b32 v30, 16, v15
    v_and_b32 v31, 0xffff0000, v15
    v_add_f32 v6, v16, v17
    v_add_f32 v6, v6, v18
    v_add_f32 v6, v6, v19
    v_add_f32 v6, v6, v20
    v_add_f32 v6, v6, v21
    v_add_f32 v6, v6, v22
    v_add_f32 v6, v6, v23
    v_add_f32 v6, v6, v24
    v_add_f32 v6, v6, v25
    v_add_f32 v6, v6, v26
    v_add_f32 v6, v6, v27
    v_add_f32 v6, v6, v28
    v_add_f32 v6, v6, v29
    v_add_f32 v6, v6, v30
    v_add_f32 v6, v6, v31
    ds_swizzle_b32 v7, v6 offset:1055
    s_waitcnt lgkmcnt(0)
    v_add_f32 v6, v6, v7
    ds_swizzle_b32 v7, v6 offset:2079
    s_waitcnt lgkmcnt(0)
    v_add_f32 v6, v6, v7
    ds_swizzle_b32 v7, v6 offset:4127
    s_waitcnt lgkmcnt(0)
    v_add_f32 v6, v6, v7
    ds_swizzle_b32 v7, v6 offset:8223
    s_waitcnt lgkmcnt(0)
    v_add_f32 v6, v6, v7
    ds_swizzle_b32 v7, v6 offset:16415
    s_waitcnt lgkmcnt(0)
    v_add_f32 v6, v6, v7
    s_nop 1
    v_readlane_b32 s40, v6, 0
    v_readlane_b32 s41, v6, 32
    s_nop 3
    v_mov_b32 v7, s41
    v_add_f32 v6, s40, v7
    v_mul_f32 v6, 0x3a800000, v6
    v_sub_f32 v16, v16, v6
    v_sub_f32 v17, v17, v6
    v_sub_f32 v18, v18, v6
    v_sub_f32 v19, v19, v6
    v_sub_f32 v20, v20, v6
    v_sub_f32 v21, v21, v6
    v_sub_f32 v22, v22, v6
    v_sub_f32 v23, v23, v6
    v_sub_f32 v24, v24, v6
    v_sub_f32 v25, v25, v6
    v_sub_f32 v26, v26, v6
    v_sub_f32 v27, v27, v6
    v_sub_f32 v28, v28, v6
    v_sub_f32 v29, v29, v6
    v_sub_f32 v30, v30, v6
    v_sub_f32 v31, v31, v6
    v_mul_f32 v6, v16, v16
    v_fmac_f32 v6, v17, v17
    v_fmac_f32 v6, v18, v18
    v_fmac_f32 v6, v19, v19
    v_fmac_f32 v6, v20, v20
    v_fmac_f32 v6, v21, v21
    v_fmac_f32 v6, v22, v22
    v_fmac_f32 v6, v23, v23
    v_fmac_f32 v6, v24, v24
    v_fmac_f32 v6, v25, v25
    v_fmac_f32 v6, v26, v26
    v_fmac_f32 v6, v27, v27
    v_fmac_f32 v6, v28, v28
    v_fmac_f32 v6, v29, v29
    v_fmac_f32 v6, v30, v30
    v_fmac_f32 v6, v31, v31
    ds_swizzle_b32 v7, v6 offset:1055
    s_waitcnt lgkmcnt(0)
    v_add_f32 v6, v6, v7
    ds_swizzle_b32 v7, v6 offset:2079
    s_waitcnt lgkmcnt(0)
    v_add_f32 v6, v6, v7
    ds_swizzle_b32 v7, v6 offset:4127
    s_waitcnt lgkmcnt(0)
    v_add_f32 v6, v6, v7
    ds_swizzle_b32 v7, v6 offset:8223
    s_waitcnt lgkmcnt(0)
    v_add_f32 v6, v6, v7
    ds_swizzle_b32 v7, v6 offset:16415
    s_waitcnt lgkmcnt(0)
    v_add_f32 v6, v6, v7
    s_nop 1
    v_readlane_b32 s40, v6, 0
    v_readlane_b32 s41, v6, 32
    s_nop 3
    v_mov_b32 v7, s41
    v_add_f32 v6, s40, v7
    v_mov_b32 v7, 0x3727c5ac
    v_fmac_f32 v7, 0x3a800000, v6
    v_rsq_f32 v7, v7
    s_nop 1
    v_mul_f32 v16, v16, v7
    v_mul_f32 v17, v17, v7
    v_mul_f32 v18, v18, v7
    v_mul_f32 v19, v19, v7
    v_mul_f32 v20, v20, v7
    v_mul_f32 v21, v21, v7
    v_mul_f32 v22, v22, v7
    v_mul_f32 v23, v23, v7
    v_mul_f32 v24, v24, v7
    v_mul_f32 v25, v25, v7
    v_mul_f32 v26, v26, v7
    v_mul_f32 v27, v27, v7
    v_mul_f32 v28, v28, v7
    v_mul_f32 v29, v29, v7
    v_mul_f32 v30, v30, v7
    v_mul_f32 v31, v31, v7
    s_nop 1
    v_cvt_pk_bf16_f32 v32, v16, v17
    v_cvt_pk_bf16_f32 v33, v18, v19
    v_cvt_pk_bf16_f32 v34, v20, v21
    v_cvt_pk_bf16_f32 v35, v22, v23
    v_cvt_pk_bf16_f32 v36, v24, v25
    v_cvt_pk_bf16_f32 v37, v26, v27
    v_cvt_pk_bf16_f32 v38, v28, v29
    v_cvt_pk_bf16_f32 v39, v30, v31
    s_nop 1
    buffer_store_dwordx4 v[32:35], v3, s[16:19], 0 offen
    buffer_store_dwordx4 v[36:39], v3, s[16:19], 0 offen offset:1024
L_ln_two_kernel_end:
    s_endpgm
.globl ln_red_kernel
.p2align 8
.type ln_red_kernel,@function
ln_red_kernel:
    s_cmp_ge_u32 s2, 512
    s_cbranch_scc1 L_ln_red_kernel_end
    s_load_dwordx2 s[4:5], s[0:1], 80
    s_load_dwordx2 s[6:7], s[0:1], 56
    v_and_b32 v1, 63, v0
    v_lshrrev_b32 v2, 6, v0
    s_lshl_b32 s3, s2, 2
    v_add_u32 v2, s3, v2
    v_lshlrev_b32 v3, 11, v2
    v_lshl_add_u32 v3, v1, 4, v3
    v_lshlrev_b32 v4, 12, v2
    v_lshl_add_u32 v4, v1, 5, v4
    v_lshlrev_b32 v5, 4, v1
    s_waitcnt lgkmcnt(0)
    s_add_u32 s12, s4, 0
    s_addc_u32 s13, s5, 0
    s_mov_b32 s14, 4194304
    s_mov_b32 s15, 0x00020000
    s_add_u32 s16, s4, 4194304
    s_addc_u32 s17, s5, 0
    s_mov_b32 s18, 4194304
    s_mov_b32 s19, 0x00020000
    s_add_u32 s20, s6, 0
    s_addc_u32 s21, s7, 0
    s_mov_b32 s22, 2048
    s_mov_b32 s23, 0x00020000
    s_add_u32 s24, s4, 33554432
    s_addc_u32 s25, s5, 0
    s_mov_b32 s26, 8388608
    s_mov_b32 s27, 0x00020000
    s_add_u32 s28, s4, 41943040
    s_addc_u32 s29, s5, 0
    s_mov_b32 s30, 8388608
    s_mov_b32 s31, 0x00020000
    buffer_load_dwordx4 v[8:11], v3, s[12:15], 0 offen
    buffer_load_dwordx4 v[12:15], v3, s[12:15], 0 offen offset:1024
    buffer_load_dwordx4 v[48:51], v4, s[24:27], 0 offen offset:0
    buffer_load_dwordx4 v[52:55], v4, s[24:27], 0 offen offset:16
    buffer_load_dwordx4 v[64:67], v4, s[28:31], 0 offen offset:0
    buffer_load_dwordx4 v[68:71], v4, s[28:31], 0 offen offset:16
    buffer_load_dwordx4 v[80:83], v5, s[20:23], 0 offen offset:0
    buffer_load_dwordx4 v[56:59], v4, s[24:27], 0 offen offset:2048
    buffer_load_dwordx4 v[60:63], v4, s[24:27], 0 offen offset:2064
    buffer_load_dwordx4 v[72:75], v4, s[28:31], 0 offen offset:2048
    buffer_load_dwordx4 v[76:79], v4, s[28:31], 0 offen offset:2064
    buffer_load_dwordx4 v[84:87], v5, s[20:23], 0 offen offset:1024
    s_waitcnt vmcnt(0)
    v_lshlrev_b32 v16, 16, v8
    v_and_b32 v17, 0xffff0000, v8
    v_lshlrev_b32 v18, 16, v9
    v_and_b32 v19, 0xffff0000, v9
    v_lshlrev_b32 v20, 16, v10
    v_and_b32 v21, 0xffff0000, v10
    v_lshlrev_b32 v22, 16, v11
    v_and_b32 v23, 0xffff0000, v11
    v_lshlrev_b32 v24, 16, v12
    v_and_b32 v25, 0xffff0000, v12
    v_lshlrev_b32 v26, 16, v13
    v_and_b32 v27, 0xffff0000, v13
    v_lshlrev_b32 v28, 16, v14
    v_and_b32 v29, 0xffff0000, v14
    v_lshlrev_b32 v30, 16, v15
    v_and_b32 v31, 0xffff0000, v15
    v_add_f32 v48, v48, v64
    v_add_f32 v49, v49, v65
    v_add_f32 v50, v50, v66
    v_add_f32 v51, v51, v67
    v_add_f32 v52, v52, v68
    v_add_f32 v53, v53, v69
    v_add_f32 v54, v54, v70
    v_add_f32 v55, v55, v71
    v_add_f32 v56, v56, v72
    v_add_f32 v57, v57, v73
    v_add_f32 v58, v58, v74
    v_add_f32 v59, v59, v75
    v_add_f32 v60, v60, v76
    v_add_f32 v61, v61, v77
    v_add_f32 v62, v62, v78
    v_add_f32 v63, v63, v79
    v_cvt_pk_bf16_f32 v64, v48, v49
    v_cvt_pk_bf16_f32 v65, v50, v51
    v_cvt_pk_bf16_f32 v66, v52, v53
    v_cvt_pk_bf16_f32 v67, v54, v55
    v_cvt_pk_bf16_f32 v68, v56, v57
    v_cvt_pk_bf16_f32 v69, v58, v59
    v_cvt_pk_bf16_f32 v70, v60, v61
    v_cvt_pk_bf16_f32 v71, v62, v63
    v_lshlrev_b32 v48, 16, v64
    v_and_b32 v49, 0xffff0000, v64
    v_lshlrev_b32 v50, 16, v65
    v_and_b32 v51, 0xffff0000, v65
    v_lshlrev_b32 v52, 16, v66
    v_and_b32 v53, 0xffff0000, v66
    v_lshlrev_b32 v54, 16, v67
    v_and_b32 v55, 0xffff0000, v67
    v_lshlrev_b32 v56, 16, v68
    v_and_b32 v57, 0xffff0000, v68
    v_lshlrev_b32 v58, 16, v69
    v_and_b32 v59, 0xffff0000, v69
    v_lshlrev_b32 v60, 16, v70
    v_and_b32 v61, 0xffff0000, v70
    v_lshlrev_b32 v62, 16, v71
    v_and_b32 v63, 0xffff0000, v71
    v_lshlrev_b32 v64, 16, v80
    v_and_b32 v65, 0xffff0000, v80
    v_lshlrev_b32 v66, 16, v81
    v_and_b32 v67, 0xffff0000, v81
    v_lshlrev_b32 v68, 16, v82
    v_and_b32 v69, 0xffff0000, v82
    v_lshlrev_b32 v70, 16, v83
    v_and_b32 v71, 0xffff0000, v83
    v_lshlrev_b32 v72, 16, v84
    v_and_b32 v73, 0xffff0000, v84
    v_lshlrev_b32 v74, 16, v85
    v_and_b32 v75, 0xffff0000, v85
    v_lshlrev_b32 v76, 16, v86
    v_and_b32 v77, 0xffff0000, v86
    v_lshlrev_b32 v78, 16, v87
    v_and_b32 v79, 0xffff0000, v87
    v_add_f32 v48, v48, v64
    v_add_f32 v49, v49, v65
    v_add_f32 v50, v50, v66
    v_add_f32 v51, v51, v67
    v_add_f32 v52, v52, v68
    v_add_f32 v53, v53, v69
    v_add_f32 v54, v54, v70
    v_add_f32 v55, v55, v71
    v_add_f32 v56, v56, v72
    v_add_f32 v57, v57, v73
    v_add_f32 v58, v58, v74
    v_add_f32 v59, v59, v75
    v_add_f32 v60, v60, v76
    v_add_f32 v61, v61, v77
    v_add_f32 v62, v62, v78
    v_add_f32 v63, v63, v79
    v_cvt_pk_bf16_f32 v64, v48, v49
    v_cvt_pk_bf16_f32 v65, v50, v51
    v_cvt_pk_bf16_f32 v66, v52, v53
    v_cvt_pk_bf16_f32 v67, v54, v55
    v_cvt_pk_bf16_f32 v68, v56, v57
    v_cvt_pk_bf16_f32 v69, v58, v59
    v_cvt_pk_bf16_f32 v70, v60, v61
    v_cvt_pk_bf16_f32 v71, v62, v63
    v_lshlrev_b32 v48, 16, v64
    v_and_b32 v49, 0xffff0000, v64
    v_lshlrev_b32 v50, 16, v65
    v_and_b32 v51, 0xffff0000, v65
    v_lshlrev_b32 v52, 16, v66
    v_and_b32 v53, 0xffff0000, v66
    v_lshlrev_b32 v54, 16, v67
    v_and_b32 v55, 0xffff0000, v67
    v_lshlrev_b32 v56, 16, v68
    v_and_b32 v57, 0xffff0000, v68
    v_lshlrev_b32 v58, 16, v69
    v_and_b32 v59, 0xffff0000, v69
    v_lshlrev_b32 v60, 16, v70
    v_and_b32 v61, 0xffff0000, v70
    v_lshlrev_b32 v62, 16, v71
    v_and_b32 v63, 0xffff0000, v71
    v_add_f32 v16, v16, v48
    v_add_f32 v17, v17, v49
    v_add_f32 v18, v18, v50
    v_add_f32 v19, v19, v51
    v_add_f32 v20, v20, v52
    v_add_f32 v21, v21, v53
    v_add_f32 v22, v22, v54
    v_add_f32 v23, v23, v55
    v_add_f32 v24, v24, v56
    v_add_f32 v25, v25, v57
    v_add_f32 v26, v26, v58
    v_add_f32 v27, v27, v59
    v_add_f32 v28, v28, v60
    v_add_f32 v29, v29, v61
    v_add_f32 v30, v30, v62
    v_add_f32 v31, v31, v63
    v_cvt_pk_bf16_f32 v8, v16, v17
    v_cvt_pk_bf16_f32 v9, v18, v19
    v_cvt_pk_bf16_f32 v10, v20, v21
    v_cvt_pk_bf16_f32 v11, v22, v23
    v_cvt_pk_bf16_f32 v12, v24, v25
    v_cvt_pk_bf16_f32 v13, v26, v27
    v_cvt_pk_bf16_f32 v14, v28, v29
    v_cvt_pk_bf16_f32 v15, v30, v31
    v_lshlrev_b32 v16, 16, v8
    v_and_b32 v17, 0xffff0000, v8
    v_lshlrev_b32 v18, 16, v9
    v_and_b32 v19, 0xffff0000, v9
    v_lshlrev_b32 v20, 16, v10
    v_and_b32 v21, 0xffff0000, v10
    v_lshlrev_b32 v22, 16, v11
    v_and_b32 v23, 0xffff0000, v11
    v_lshlrev_b32 v24, 16, v12
    v_and_b32 v25, 0xffff0000, v12
    v_lshlrev_b32 v26, 16, v13
    v_and_b32 v27, 0xffff0000, v13
    v_lshlrev_b32 v28, 16, v14
    v_and_b32 v29, 0xffff0000, v14
    v_lshlrev_b32 v30, 16, v15
    v_and_b32 v31, 0xffff0000, v15
    buffer_store_dwordx4 v[8:11], v3, s[12:15], 0 offen
    buffer_store_dwordx4 v[12:15], v3, s[12:15], 0 offen offset:1024
    v_add_f32 v6, v16, v17
    v_add_f32 v6, v6, v18
    v_add_f32 v6, v6, v19
    v_add_f32 v6, v6, v20
    v_add_f32 v6, v6, v21
    v_add_f32 v6, v6, v22
    v_add_f32 v6, v6, v23
    v_add_f32 v6, v6, v24
    v_add_f32 v6, v6, v25
    v_add_f32 v6, v6, v26
    v_add_f32 v6, v6, v27
    v_add_f32 v6, v6, v28
    v_add_f32 v6, v6, v29
    v_add_f32 v6, v6, v30
    v_add_f32 v6, v6, v31
    ds_swizzle_b32 v7, v6 offset:1055
    s_waitcnt lgkmcnt(0)
    v_add_f32 v6, v6, v7
    ds_swizzle_b32 v7, v6 offset:2079
    s_waitcnt lgkmcnt(0)
    v_add_f32 v6, v6, v7
    ds_swizzle_b32 v7, v6 offset:4127
    s_waitcnt lgkmcnt(0)
    v_add_f32 v6, v6, v7
    ds_swizzle_b32 v7, v6 offset:8223
    s_waitcnt lgkmcnt(0)
    v_add_f32 v6, v6, v7
    ds_swizzle_b32 v7, v6 offset:16415
    s_waitcnt lgkmcnt(0)
    v_add_f32 v6, v6, v7
    s_nop 1
    v_readlane_b32 s40, v6, 0
    v_readlane_b32 s41, v6, 32
    s_nop 3
    v_mov_b32 v7, s41
    v_add_f32 v6, s40, v7
    v_mul_f32 v6, 0x3a800000, v6
    v_sub_f32 v16, v16, v6
    v_sub_f32 v17, v17, v6
    v_sub_f32 v18, v18, v6
    v_sub_f32 v19, v19, v6
    v_sub_f32 v20, v20, v6
    v_sub_f32 v21, v21, v6
    v_sub_f32 v22, v22, v6
    v_sub_f32 v23, v23, v6
    v_sub_f32 v24, v24, v6
    v_sub_f32 v25, v25, v6
    v_sub_f32 v26, v26, v6
    v_sub_f32 v27, v27, v6
    v_sub_f32 v28, v28, v6
    v_sub_f32 v29, v29, v6
    v_sub_f32 v30, v30, v6
    v_sub_f32 v31, v31, v6
    v_mul_f32 v6, v16, v16
    v_fmac_f32 v6, v17, v17
    v_fmac_f32 v6, v18, v18
    v_fmac_f32 v6, v19, v19
    v_fmac_f32 v6, v20, v20
    v_fmac_f32 v6, v21, v21
    v_fmac_f32 v6, v22, v22
    v_fmac_f32 v6, v23, v23
    v_fmac_f32 v6, v24, v24
    v_fmac_f32 v6, v25, v25
    v_fmac_f32 v6, v26, v26
    v_fmac_f32 v6, v27, v27
    v_fmac_f32 v6, v28, v28
    v_fmac_f32 v6, v29, v29
    v_fmac_f32 v6, v30, v30
    v_fmac_f32 v6, v31, v31
    ds_swizzle_b32 v7, v6 offset:1055
    s_waitcnt lgkmcnt(0)
    v_add_f32 v6, v6, v7
    ds_swizzle_b32 v7, v6 offset:2079
    s_waitcnt lgkmcnt(0)
    v_add_f32 v6, v6, v7
    ds_swizzle_b32 v7, v6 offset:4127
    s_waitcnt lgkmcnt(0)
    v_add_f32 v6, v6, v7
    ds_swizzle_b32 v7, v6 offset:8223
    s_waitcnt lgkmcnt(0)
    v_add_f32 v6, v6, v7
    ds_swizzle_b32 v7, v6 offset:16415
    s_waitcnt lgkmcnt(0)
    v_add_f32 v6, v6, v7
    s_nop 1
    v_readlane_b32 s40, v6, 0
    v_readlane_b32 s41, v6, 32
    s_nop 3
    v_mov_b32 v7, s41
    v_add_f32 v6, s40, v7
    v_mov_b32 v7, 0x3727c5ac
    v_fmac_f32 v7, 0x3a800000, v6
    v_rsq_f32 v7, v7
    s_nop 1
    v_mul_f32 v16, v16, v7
    v_mul_f32 v17, v17, v7
    v_mul_f32 v18, v18, v7
    v_mul_f32 v19, v19, v7
    v_mul_f32 v20, v20, v7
    v_mul_f32 v21, v21, v7
    v_mul_f32 v22, v22, v7
    v_mul_f32 v23, v23, v7
    v_mul_f32 v24, v24, v7
    v_mul_f32 v25, v25, v7
    v_mul_f32 v26, v26, v7
    v_mul_f32 v27, v27, v7
    v_mul_f32 v28, v28, v7
    v_mul_f32 v29, v29, v7
    v_mul_f32 v30, v30, v7
    v_mul_f32 v31, v31, v7
    s_nop 1
    v_cvt_pk_bf16_f32 v32, v16, v17
    v_cvt_pk_bf16_f32 v33, v18, v19
    v_cvt_pk_bf16_f32 v34, v20, v21
    v_cvt_pk_bf16_f32 v35, v22, v23
    v_cvt_pk_bf16_f32 v36, v24, v25
    v_cvt_pk_bf16_f32 v37, v26, v27
    v_cvt_pk_bf16_f32 v38, v28, v29
    v_cvt_pk_bf16_f32 v39, v30, v31
    s_nop 1
    buffer_store_dwordx4 v[32:35], v3, s[16:19], 0 offen
    buffer_store_dwordx4 v[36:39], v3, s[16:19], 0 offen offset:1024
L_ln_red_kernel_end:
    s_endpgm
.globl ln_out_kernel
.p2align 8
.type ln_out_kernel,@function
ln_out_kernel:
    s_cmp_ge_u32 s2, 512
    s_cbranch_scc1 L_ln_out_kernel_end
    s_load_dwordx2 s[4:5], s[0:1], 80
    s_load_dwordx2 s[6:7], s[0:1], 56
    s_load_dwordx2 s[8:9], s[0:1], 64
    v_and_b32 v1, 63, v0
    v_lshrrev_b32 v2, 6, v0
    s_lshl_b32 s3, s2, 2
    v_add_u32 v2, s3, v2
    v_lshlrev_b32 v3, 11, v2
    v_lshl_add_u32 v3, v1, 4, v3
    v_lshlrev_b32 v4, 12, v2
    v_lshl_add_u32 v4, v1, 5, v4
    v_lshlrev_b32 v5, 4, v1
    s_waitcnt lgkmcnt(0)
    s_add_u32 s12, s4, 0
    s_addc_u32 s13, s5, 0
    s_mov_b32 s14, 4194304
    s_mov_b32 s15, 0x00020000
    s_add_u32 s16, s4, 4194304
    s_addc_u32 s17, s5, 0
    s_mov_b32 s18, 4194304
    s_mov_b32 s19, 0x00020000
    s_add_u32 s20, s6, 0
    s_addc_u32 s21, s7, 0
    s_mov_b32 s22, 2048
    s_mov_b32 s23, 0x00020000
    s_add_u32 s24, s4, 33554432
    s_addc_u32 s25, s5, 0
    s_mov_b32 s26, 8388608
    s_mov_b32 s27, 0x00020000
    s_add_u32 s28, s4, 41943040
    s_addc_u32 s29, s5, 0
    s_mov_b32 s30, 8388608
    s_mov_b32 s31, 0x00020000
    s_add_u32 s32, s8, 0
    s_addc_u32 s33, s9, 0
    s_mov_b32 s34, 4194304
    s_mov_b32 s35, 0x00020000
    buffer_load_dwordx4 v[8:11], v3, s[12:15], 0 offen
    buffer_load_dwordx4 v[12:15], v3, s[12:15], 0 offen offset:1024
    buffer_load_dwordx4 v[48:51], v4, s[24:27], 0 offen offset:0
    buffer_load_dwordx4 v[52:55], v4, s[24:27], 0 offen offset:16
    buffer_load_dwordx4 v[64:67], v4, s[28:31], 0 offen offset:0
    buffer_load_dwordx4 v[68:71], v4, s[28:31], 0 offen offset:16
    buffer_load_dwordx4 v[80:83], v5, s[20:23], 0 offen offset:0
    buffer_load_dwordx4 v[56:59], v4, s[24:27], 0 offen offset:2048
    buffer_load_dwordx4 v[60:63], v4, s[24:27], 0 offen offset:2064
    buffer_load_dwordx4 v[72:75], v4, s[28:31], 0 offen offset:2048
    buffer_load_dwordx4 v[76:79], v4, s[28:31], 0 offen offset:2064
    buffer_load_dwordx4 v[84:87], v5, s[20:23], 0 offen offset:1024
    s_waitcnt vmcnt(0)
    v_lshlrev_b32 v16, 16, v8
    v_and_b32 v17, 0xffff0000, v8
    v_lshlrev_b32 v18, 16, v9
    v_and_b32 v19, 0xffff0000, v9
    v_lshlrev_b32 v20, 16, v10
    v_and_b32 v21, 0xffff0000, v10
    v_lshlrev_b32 v22, 16, v11
    v_and_b32 v23, 0xffff0000, v11
    v_lshlrev_b32 v24, 16, v12
    v_and_b32 v25, 0xffff0000, v12
    v_lshlrev_b32 v26, 16, v13
    v_and_b32 v27, 0xffff0000, v13
    v_lshlrev_b32 v28, 16, v14
    v_and_b32 v29, 0xffff0000, v14
    v_lshlrev_b32 v30, 16, v15
    v_and_b32 v31, 0xffff0000, v15
    v_add_f32 v48, v48, v64
    v_add_f32 v49, v49, v65
    v_add_f32 v50, v50, v66
    v_add_f32 v51, v51, v67
    v_add_f32 v52, v52, v68
    v_add_f32 v53, v53, v69
    v_add_f32 v54, v54, v70
    v_add_f32 v55, v55, v71
    v_add_f32 v56, v56, v72
    v_add_f32 v57, v57, v73
    v_add_f32 v58, v58, v74
    v_add_f32 v59, v59, v75
    v_add_f32 v60, v60, v76
    v_add_f32 v61, v61, v77
    v_add_f32 v62, v62, v78
    v_add_f32 v63, v63, v79
    v_cvt_pk_bf16_f32 v64, v48, v49
    v_cvt_pk_bf16_f32 v65, v50, v51
    v_cvt_pk_bf16_f32 v66, v52, v53
    v_cvt_pk_bf16_f32 v67, v54, v55
    v_cvt_pk_bf16_f32 v68, v56, v57
    v_cvt_pk_bf16_f32 v69, v58, v59
    v_cvt_pk_bf16_f32 v70, v60, v61
    v_cvt_pk_bf16_f32 v71, v62, v63
    v_lshlrev_b32 v48, 16, v64
    v_and_b32 v49, 0xffff0000, v64
    v_lshlrev_b32 v50, 16, v65
    v_and_b32 v51, 0xffff0000, v65
    v_lshlrev_b32 v52, 16, v66
    v_and_b32 v53, 0xffff0000, v66
    v_lshlrev_b32 v54, 16, v67
    v_and_b32 v55, 0xffff0000, v67
    v_lshlrev_b32 v56, 16, v68
    v_and_b32 v57, 0xffff0000, v68
    v_lshlrev_b32 v58, 16, v69
    v_and_b32 v59, 0xffff0000, v69
    v_lshlrev_b32 v60, 16, v70
    v_and_b32 v61, 0xffff0000, v70
    v_lshlrev_b32 v62, 16, v71
    v_and_b32 v63, 0xffff0000, v71
    v_lshlrev_b32 v64, 16, v80
    v_and_b32 v65, 0xffff0000, v80
    v_lshlrev_b32 v66, 16, v81
    v_and_b32 v67, 0xffff0000, v81
    v_lshlrev_b32 v68, 16, v82
    v_and_b32 v69, 0xffff0000, v82
    v_lshlrev_b32 v70, 16, v83
    v_and_b32 v71, 0xffff0000, v83
    v_lshlrev_b32 v72, 16, v84
    v_and_b32 v73, 0xffff0000, v84
    v_lshlrev_b32 v74, 16, v85
    v_and_b32 v75, 0xffff0000, v85
    v_lshlrev_b32 v76, 16, v86
    v_and_b32 v77, 0xffff0000, v86
    v_lshlrev_b32 v78, 16, v87
    v_and_b32 v79, 0xffff0000, v87
    v_add_f32 v48, v48, v64
    v_add_f32 v49, v49, v65
    v_add_f32 v50, v50, v66
    v_add_f32 v51, v51, v67
    v_add_f32 v52, v52, v68
    v_add_f32 v53, v53, v69
    v_add_f32 v54, v54, v70
    v_add_f32 v55, v55, v71
    v_add_f32 v56, v56, v72
    v_add_f32 v57, v57, v73
    v_add_f32 v58, v58, v74
    v_add_f32 v59, v59, v75
    v_add_f32 v60, v60, v76
    v_add_f32 v61, v61, v77
    v_add_f32 v62, v62, v78
    v_add_f32 v63, v63, v79
    v_cvt_pk_bf16_f32 v64, v48, v49
    v_cvt_pk_bf16_f32 v65, v50, v51
    v_cvt_pk_bf16_f32 v66, v52, v53
    v_cvt_pk_bf16_f32 v67, v54, v55
    v_cvt_pk_bf16_f32 v68, v56, v57
    v_cvt_pk_bf16_f32 v69, v58, v59
    v_cvt_pk_bf16_f32 v70, v60, v61
    v_cvt_pk_bf16_f32 v71, v62, v63
    v_lshlrev_b32 v48, 16, v64
    v_and_b32 v49, 0xffff0000, v64
    v_lshlrev_b32 v50, 16, v65
    v_and_b32 v51, 0xffff0000, v65
    v_lshlrev_b32 v52, 16, v66
    v_and_b32 v53, 0xffff0000, v66
    v_lshlrev_b32 v54, 16, v67
    v_and_b32 v55, 0xffff0000, v67
    v_lshlrev_b32 v56, 16, v68
    v_and_b32 v57, 0xffff0000, v68
    v_lshlrev_b32 v58, 16, v69
    v_and_b32 v59, 0xffff0000, v69
    v_lshlrev_b32 v60, 16, v70
    v_and_b32 v61, 0xffff0000, v70
    v_lshlrev_b32 v62, 16, v71
    v_and_b32 v63, 0xffff0000, v71
    v_add_f32 v16, v16, v48
    v_add_f32 v17, v17, v49
    v_add_f32 v18, v18, v50
    v_add_f32 v19, v19, v51
    v_add_f32 v20, v20, v52
    v_add_f32 v21, v21, v53
    v_add_f32 v22, v22, v54
    v_add_f32 v23, v23, v55
    v_add_f32 v24, v24, v56
    v_add_f32 v25, v25, v57
    v_add_f32 v26, v26, v58
    v_add_f32 v27, v27, v59
    v_add_f32 v28, v28, v60
    v_add_f32 v29, v29, v61
    v_add_f32 v30, v30, v62
    v_add_f32 v31, v31, v63
    v_cvt_pk_bf16_f32 v8, v16, v17
    v_cvt_pk_bf16_f32 v9, v18, v19
    v_cvt_pk_bf16_f32 v10, v20, v21
    v_cvt_pk_bf16_f32 v11, v22, v23
    v_cvt_pk_bf16_f32 v12, v24, v25
    v_cvt_pk_bf16_f32 v13, v26, v27
    v_cvt_pk_bf16_f32 v14, v28, v29
    v_cvt_pk_bf16_f32 v15, v30, v31
    v_lshlrev_b32 v16, 16, v8
    v_and_b32 v17, 0xffff0000, v8
    v_lshlrev_b32 v18, 16, v9
    v_and_b32 v19, 0xffff0000, v9
    v_lshlrev_b32 v20, 16, v10
    v_and_b32 v21, 0xffff0000, v10
    v_lshlrev_b32 v22, 16, v11
    v_and_b32 v23, 0xffff0000, v11
    v_lshlrev_b32 v24, 16, v12
    v_and_b32 v25, 0xffff0000, v12
    v_lshlrev_b32 v26, 16, v13
    v_and_b32 v27, 0xffff0000, v13
    v_lshlrev_b32 v28, 16, v14
    v_and_b32 v29, 0xffff0000, v14
    v_lshlrev_b32 v30, 16, v15
    v_and_b32 v31, 0xffff0000, v15
    buffer_store_dwordx4 v[8:11], v3, s[32:35], 0 offen
    buffer_store_dwordx4 v[12:15], v3, s[32:35], 0 offen offset:1024
L_ln_out_kernel_end:
    s_endpgm
.globl attn_o_kernel
.p2align 8
.type attn_o_kernel,@function
attn_o_kernel:
    s_cmp_ge_u32 s2, 256
    s_cbranch_scc1 L_attn_o_kernel_end
    s_load_dwordx2 s[4:5], s[0:1], 80
    s_lshr_b32 s20, s2, 3
    s_and_b32 s21, s2, 7
    s_waitcnt lgkmcnt(0)
    s_add_u32 s8, s4, 50331648
    s_addc_u32 s9, s5, 0
    s_mov_b32 s10, 2162688
    s_mov_b32 s11, 0x00020000
    s_add_u32 s12, s4, 8388608
    s_addc_u32 s13, s5, 0
    s_mov_b32 s14, 4194304
    s_mov_b32 s15, 0x00020000
    s_add_u32 s16, s4, 12582912
    s_addc_u32 s17, s5, 0
    s_mov_b32 s18, 4194304
    s_mov_b32 s19, 0x00020000
    s_mul_i32 s22, s20, 4224
    s_mov_b32 s25, 135168
    s_mov_b32 s26, 270336
    s_mov_b32 s27, 405504
    s_mov_b32 s28, 540672
    s_mov_b32 s29, 675840
    s_mov_b32 s30, 811008
    s_mov_b32 s31, 946176
    s_mov_b32 s32, 1081344
    s_mov_b32 s33, 1216512
    s_mov_b32 s34, 1351680
    s_mov_b32 s35, 1486848
    s_mov_b32 s36, 1622016
    s_mov_b32 s37, 1757184
    s_mov_b32 s38, 1892352
    s_mov_b32 s39, 2027520
    s_mov_b32 s47, 32768
    s_mov_b32 s48, 65536
    s_mov_b32 s49, 98304
    v_lshlrev_b32 v1, 4, v0
    v_add_u32 v1, s22, v1
    buffer_load_dwordx4 v[8:11], v1, s[8:11], 0 offen offset:0
    buffer_load_dwordx4 v[12:15], v1, s[8:11], s25 offen
    buffer_load_dwordx4 v[16:19], v1, s[8:11], s26 offen
    buffer_load_dwordx4 v[20:23], v1, s[8:11], s27 offen
    buffer_load_dwordx4 v[24:27], v1, s[8:11], s28 offen
    buffer_load_dwordx4 v[28:31], v1, s[8:11], s29 offen
    buffer_load_dwordx4 v[32:35], v1, s[8:11], s30 offen
    buffer_load_dwordx4 v[36:39], v1, s[8:11], s31 offen
    buffer_load_dwordx4 v[40:43], v1, s[8:11], s32 offen
    buffer_load_dwordx4 v[44:47], v1, s[8:11], s33 offen
    buffer_load_dwordx4 v[48:51], v1, s[8:11], s34 offen
    buffer_load_dwordx4 v[52:55], v1, s[8:11], s35 offen
    buffer_load_dwordx4 v[56:59], v1, s[8:11], s36 offen
    buffer_load_dwordx4 v[60:63], v1, s[8:11], s37 offen
    buffer_load_dwordx4 v[64:67], v1, s[8:11], s38 offen
    buffer_load_dwordx4 v[68:71], v1, s[8:11], s39 offen
    s_waitcnt vmcnt(0)
    v_add_f32 v8, v8, v12
    v_add_f32 v9, v9, v13
    v_add_f32 v10, v10, v14
    v_add_f32 v11, v11, v15
    v_add_f32 v8, v8, v16
    v_add_f32 v9, v9, v17
    v_add_f32 v10, v10, v18
    v_add_f32 v11, v11, v19
    v_add_f32 v8, v8, v20
    v_add_f32 v9, v9, v21
    v_add_f32 v10, v10, v22
    v_add_f32 v11, v11, v23
    v_add_f32 v8, v8, v24
    v_add_f32 v9, v9, v25
    v_add_f32 v10, v10, v26
    v_add_f32 v11, v11, v27
    v_add_f32 v8, v8, v28
    v_add_f32 v9, v9, v29
    v_add_f32 v10, v10, v30
    v_add_f32 v11, v11, v31
    v_add_f32 v8, v8, v32
    v_add_f32 v9, v9, v33
    v_add_f32 v10, v10, v34
    v_add_f32 v11, v11, v35
    v_add_f32 v8, v8, v36
    v_add_f32 v9, v9, v37
    v_add_f32 v10, v10, v38
    v_add_f32 v11, v11, v39
    v_add_f32 v8, v8, v40
    v_add_f32 v9, v9, v41
    v_add_f32 v10, v10, v42
    v_add_f32 v11, v11, v43
    v_add_f32 v8, v8, v44
    v_add_f32 v9, v9, v45
    v_add_f32 v10, v10, v46
    v_add_f32 v11, v11, v47
    v_add_f32 v8, v8, v48
    v_add_f32 v9, v9, v49
    v_add_f32 v10, v10, v50
    v_add_f32 v11, v11, v51
    v_add_f32 v8, v8, v52
    v_add_f32 v9, v9, v53
    v_add_f32 v10, v10, v54
    v_add_f32 v11, v11, v55
    v_add_f32 v8, v8, v56
    v_add_f32 v9, v9, v57
    v_add_f32 v10, v10, v58
    v_add_f32 v11, v11, v59
    v_add_f32 v8, v8, v60
    v_add_f32 v9, v9, v61
    v_add_f32 v10, v10, v62
    v_add_f32 v11, v11, v63
    v_add_f32 v8, v8, v64
    v_add_f32 v9, v9, v65
    v_add_f32 v10, v10, v66
    v_add_f32 v11, v11, v67
    v_add_f32 v8, v8, v68
    v_add_f32 v9, v9, v69
    v_add_f32 v10, v10, v70
    v_add_f32 v11, v11, v71
    v_cvt_pk_bf16_f32 v4, v8, v9
    v_cvt_pk_bf16_f32 v5, v10, v11
    v_lshlrev_b32 v2, 3, v0
    ds_write_b64 v2, v[4:5]
    v_cmp_gt_u32 vcc, 8, v0
    s_and_saveexec_b64 s[44:45], vcc
    s_cbranch_execz L_attn_o_kernel_z
    v_lshlrev_b32 v1, 4, v0
    v_add_u32 v1, s22, v1
    v_add_u32 v1, 4096, v1
    buffer_load_dwordx4 v[8:11], v1, s[8:11], 0 offen
    buffer_load_dwordx4 v[12:15], v1, s[8:11], s25 offen
    buffer_load_dwordx4 v[16:19], v1, s[8:11], s26 offen
    buffer_load_dwordx4 v[20:23], v1, s[8:11], s27 offen
    buffer_load_dwordx4 v[24:27], v1, s[8:11], s28 offen
    buffer_load_dwordx4 v[28:31], v1, s[8:11], s29 offen
    buffer_load_dwordx4 v[32:35], v1, s[8:11], s30 offen
    buffer_load_dwordx4 v[36:39], v1, s[8:11], s31 offen
    buffer_load_dwordx4 v[40:43], v1, s[8:11], s32 offen
    buffer_load_dwordx4 v[44:47], v1, s[8:11], s33 offen
    buffer_load_dwordx4 v[48:51], v1, s[8:11], s34 offen
    buffer_load_dwordx4 v[52:55], v1, s[8:11], s35 offen
    buffer_load_dwordx4 v[56:59], v1, s[8:11], s36 offen
    buffer_load_dwordx4 v[60:63], v1, s[8:11], s37 offen
    buffer_load_dwordx4 v[64:67], v1, s[8:11], s38 offen
    buffer_load_dwordx4 v[68:71], v1, s[8:11], s39 offen
    s_waitcnt vmcnt(0)
    v_add_f32 v8, v8, v12
    v_add_f32 v9, v9, v13
    v_add_f32 v10, v10, v14
    v_add_f32 v11, v11, v15
    v_add_f32 v8, v8, v16
    v_add_f32 v9, v9, v17
    v_add_f32 v10, v10, v18
    v_add_f32 v11, v11, v19
    v_add_f32 v8, v8, v20
    v_add_f32 v9, v9, v21
    v_add_f32 v10, v10, v22
    v_add_f32 v11, v11, v23
    v_add_f32 v8, v8, v24
    v_add_f32 v9, v9, v25
    v_add_f32 v10, v10, v26
    v_add_f32 v11, v11, v27
    v_add_f32 v8, v8, v28
    v_add_f32 v9, v9, v29
    v_add_f32 v10, v10, v30
    v_add_f32 v11, v11, v31
    v_add_f32 v8, v8, v32
    v_add_f32 v9, v9, v33
    v_add_f32 v10, v10, v34
    v_add_f32 v11, v11, v35
    v_add_f32 v8, v8, v36
    v_add_f32 v9, v9, v37
    v_add_f32 v10, v10, v38
    v_add_f32 v11, v11, v39
    v_add_f32 v8, v8, v40
    v_add_f32 v9, v9, v41
    v_add_f32 v10, v10, v42
    v_add_f32 v11, v11, v43
    v_add_f32 v8, v8, v44
    v_add_f32 v9, v9, v45
    v_add_f32 v10, v10, v46
    v_add_f32 v11, v11, v47
    v_add_f32 v8, v8, v48
    v_add_f32 v9, v9, v49
    v_add_f32 v10, v10, v50
    v_add_f32 v11, v11, v51
    v_add_f32 v8, v8, v52
    v_add_f32 v9, v9, v53
    v_add_f32 v10, v10, v54
    v_add_f32 v11, v11, v55
    v_add_f32 v8, v8, v56
    v_add_f32 v9, v9, v57
    v_add_f32 v10, v10, v58
    v_add_f32 v11, v11, v59
    v_add_f32 v8, v8, v60
    v_add_f32 v9, v9, v61
    v_add_f32 v10, v10, v62
    v_add_f32 v11, v11, v63
    v_add_f32 v8, v8, v64
    v_add_f32 v9, v9, v65
    v_add_f32 v10, v10, v66
    v_add_f32 v11, v11, v67
    v_add_f32 v8, v8, v68
    v_add_f32 v9, v9, v69
    v_add_f32 v10, v10, v70
    v_add_f32 v11, v11, v71
    v_cvt_pk_bf16_f32 v4, v8, v9
    v_cvt_pk_bf16_f32 v5, v10, v11
    ds_write_b64 v2, v[4:5] offset:2048
L_attn_o_kernel_z:
    s_mov_b64 exec, s[44:45]
    s_waitcnt lgkmcnt(0)
    s_barrier
    v_and_b32 v1, 63, v0
    v_and_b32 v2, 15, v1
    v_lshrrev_b32 v3, 4, v1
    v_lshlrev_b32 v4, 6, v2
    v_lshl_add_u32 v4, v3, 4, v4
    ds_read_b128 v[8:11], v4
    ds_read_b128 v[12:15], v4 offset:1024
    v_lshlrev_b32 v5, 4, v3
    ds_read_b128 v[16:19], v5 offset:2048
    v_lshrrev_b32 v6, 6, v0
    v_lshlrev_b32 v6, 6, v6
    v_add_u32 v6, v6, v2
    s_lshl_b32 s23, s21, 8
    v_add_u32 v6, s23, v6
    v_lshlrev_b32 v6, 11, v6
    s_lshl_b32 s23, s20, 6
    v_add_u32 v6, s23, v6
    v_lshl_add_u32 v7, v3, 4, v6
    v_lshl_add_u32 v6, v3, 3, v6
    buffer_load_dwordx4 v[20:23], v7, s[12:15], 0 offen offset:0
    buffer_load_dwordx4 v[24:27], v7, s[12:15], s47 offen
    buffer_load_dwordx4 v[28:31], v7, s[12:15], s48 offen
    buffer_load_dwordx4 v[32:35], v7, s[12:15], s49 offen
    s_waitcnt vmcnt(0) lgkmcnt(0)
    v_mfma_f32_16x16x32_bf16 v[40:43], v[8:11], v[20:23], 0
    v_mfma_f32_16x16x32_bf16 v[44:47], v[12:15], v[20:23], 0
    v_mfma_f32_16x16x32_bf16 v[48:51], v[16:19], v[20:23], 0
    v_mfma_f32_16x16x32_bf16 v[56:59], v[8:11], v[24:27], 0
    v_mfma_f32_16x16x32_bf16 v[60:63], v[12:15], v[24:27], 0
    v_mfma_f32_16x16x32_bf16 v[64:67], v[16:19], v[24:27], 0
    v_mfma_f32_16x16x32_bf16 v[72:75], v[8:11], v[28:31], 0
    v_mfma_f32_16x16x32_bf16 v[76:79], v[12:15], v[28:31], 0
    v_mfma_f32_16x16x32_bf16 v[80:83], v[16:19], v[28:31], 0
    v_mfma_f32_16x16x32_bf16 v[88:91], v[8:11], v[32:35], 0
    v_mfma_f32_16x16x32_bf16 v[92:95], v[12:15], v[32:35], 0
    v_mfma_f32_16x16x32_bf16 v[96:99], v[16:19], v[32:35], 0
    s_nop 7
    s_nop 7
    v_add_f32 v48, 0x358637bd, v48
    v_rcp_f32 v48, v48
    v_add_f32 v49, 0x358637bd, v49
    v_rcp_f32 v49, v49
    v_add_f32 v50, 0x358637bd, v50
    v_rcp_f32 v50, v50
    v_add_f32 v51, 0x358637bd, v51
    v_rcp_f32 v51, v51
    s_nop 1
    v_mul_f32 v40, v40, v48
    v_mul_f32 v44, v44, v48
    v_mul_f32 v41, v41, v49
    v_mul_f32 v45, v45, v49
    v_mul_f32 v42, v42, v50
    v_mul_f32 v46, v46, v50
    v_mul_f32 v43, v43, v51
    v_mul_f32 v47, v47, v51
    v_cvt_pk_bf16_f32 v52, v40, v41
    v_cvt_pk_bf16_f32 v53, v42, v43
    v_cvt_pk_bf16_f32 v54, v44, v45
    v_cvt_pk_bf16_f32 v55, v46, v47
    buffer_store_dwordx2 v[52:53], v6, s[16:19], 0 offen
    buffer_store_dwordx2 v[54:55], v6, s[16:19], 0 offen offset:32
    v_add_f32 v64, 0x358637bd, v64
    v_rcp_f32 v64, v64
    v_add_f32 v65, 0x358637bd, v65
    v_rcp_f32 v65, v65
    v_add_f32 v66, 0x358637bd, v66
    v_rcp_f32 v66, v66
    v_add_f32 v67, 0x358637bd, v67
    v_rcp_f32 v67, v67
    s_nop 1
    v_mul_f32 v56, v56, v64
    v_mul_f32 v60, v60, v64
    v_mul_f32 v57, v57, v65
    v_mul_f32 v61, v61, v65
    v_mul_f32 v58, v58, v66
    v_mul_f32 v62, v62, v66
    v_mul_f32 v59, v59, v67
    v_mul_f32 v63, v63, v67
    v_cvt_pk_bf16_f32 v68, v56, v57
    v_cvt_pk_bf16_f32 v69, v58, v59
    v_cvt_pk_bf16_f32 v70, v60, v61
    v_cvt_pk_bf16_f32 v71, v62, v63
    buffer_store_dwordx2 v[68:69], v6, s[16:19], s47 offen
    buffer_store_dwordx2 v[70:71], v6, s[16:19], s47 offen offset:32
    v_add_f32 v80, 0x358637bd, v80
    v_rcp_f32 v80, v80
    v_add_f32 v81, 0x358637bd, v81
    v_rcp_f32 v81, v81
    v_add_f32 v82, 0x358637bd, v82
    v_rcp_f32 v82, v82
    v_add_f32 v83, 0x358637bd, v83
    v_rcp_f32 v83, v83
    s_nop 1
    v_mul_f32 v72, v72, v80
    v_mul_f32 v76, v76, v80
    v_mul_f32 v73, v73, v81
    v_mul_f32 v77, v77, v81
    v_mul_f32 v74, v74, v82
    v_mul_f32 v78, v78, v82
    v_mul_f32 v75, v75, v83
    v_mul_f32 v79, v79, v83
    v_cvt_pk_bf16_f32 v84, v72, v73
    v_cvt_pk_bf16_f32 v85, v74, v75
    v_cvt_pk_bf16_f32 v86, v76, v77
    v_cvt_pk_bf16_f32 v87, v78, v79
    buffer_store_dwordx2 v[84:85], v6, s[16:19], s48 offen
    buffer_store_dwordx2 v[86:87], v6, s[16:19], s48 offen offset:32
    v_add_f32 v96, 0x358637bd, v96
    v_rcp_f32 v96, v96
    v_add_f32 v97, 0x358637bd, v97
    v_rcp_f32 v97, v97
    v_add_f32 v98, 0x358637bd, v98
    v_rcp_f32 v98, v98
    v_add_f32 v99, 0x358637bd, v99
    v_rcp_f32 v99, v99
    s_nop 1
    v_mul_f32 v88, v88, v96
    v_mul_f32 v92, v92, v96
    v_mul_f32 v89, v89, v97
    v_mul_f32 v93, v93, v97
    v_mul_f32 v90, v90, v98
    v_mul_f32 v94, v94, v98
    v_mul_f32 v91, v91, v99
    v_mul_f32 v95, v95, v99
    v_cvt_pk_bf16_f32 v100, v88, v89
    v_cvt_pk_bf16_f32 v101, v90, v91
    v_cvt_pk_bf16_f32 v102, v92, v93
    v_cvt_pk_bf16_f32 v103, v94, v95
    buffer_store_dwordx2 v[100:101], v6, s[16:19], s49 offen
    buffer_store_dwordx2 v[102:103], v6, s[16:19], s49 offen offset:32
L_attn_o_kernel_end:
    s_endpgm
.globl gemm_qkv_kernel
.p2align 8
.type gemm_qkv_kernel,@function
gemm_qkv_kernel:
    s_cmp_ge_u32 s2, 256
    s_cbranch_scc1 L_gemm_qkv_kernel_end
    s_load_dwordx2 s[4:5], s[0:1], 80
    s_load_dwordx2 s[6:7], s[0:1], 8
    v_and_b32 v1, 63, v0
    v_lshrrev_b32 v2, 6, v0
    s_nop 0
    v_readfirstlane_b32 s24, v2
    s_and_b32 s60, s24, 4
    s_and_b32 s24, s24, 3
    s_and_b32 s25, s24, 1
    s_lshr_b32 s26, s24, 1
    s_and_b32 s40, s2, 7
    s_lshr_b32 s41, s2, 3
    s_and_b32 s42, s40, 1
    s_lshl_b32 s42, s42, 3
    s_and_b32 s43, s41, 7
    s_add_u32 s27, s42, s43
    s_lshr_b32 s42, s40, 1
    s_lshl_b32 s42, s42, 2
    s_lshr_b32 s43, s41, 3
    s_add_u32 s28, s42, s43
    s_waitcnt lgkmcnt(0)
    s_add_u32 s8, s4, 4194304
    s_addc_u32 s9, s5, 0
    s_mov_b32 s10, 4194304
    s_mov_b32 s11, 0x00020000
    s_add_u32 s12, s6, 0
    s_addc_u32 s13, s7, 0
    s_mov_b32 s14, 6291456
    s_mov_b32 s15, 0x00020000
    s_cmp_eq_u32 s60, 0
    s_cbranch_scc1 L_gemm_qkv_kernel_compute
    v_lshrrev_b32 v2, 3, v1
    v_and_b32 v3, 7, v1
    v_lshrrev_b32 v4, 4, v1
    s_lshl_b32 s40, s27, 7
    s_lshl_b32 s41, s24, 5
    s_add_u32 s40, s40, s41
    v_xor_b32 v5, v3, v4
    v_add_u32 v6, 0, v2
    v_add_u32 v6, s40, v6
    v_mul_u32_u24 v6, 2048, v6
    v_lshl_add_u32 v220, v5, 4, v6
    v_xor_b32 v5, v3, v4
    v_xor_b32 v5, 4, v5
    v_add_u32 v6, 8, v2
    v_add_u32 v6, s40, v6
    v_mul_u32_u24 v6, 2048, v6
    v_lshl_add_u32 v221, v5, 4, v6
    v_xor_b32 v5, v3, v4
    v_add_u32 v6, 16, v2
    v_add_u32 v6, s40, v6
    v_mul_u32_u24 v6, 2048, v6
    v_lshl_add_u32 v222, v5, 4, v6
    v_xor_b32 v5, v3, v4
    v_xor_b32 v5, 4, v5
    v_add_u32 v6, 24, v2
    v_add_u32 v6, s40, v6
    v_mul_u32_u24 v6, 2048, v6
    v_lshl_add_u32 v223, v5, 4, v6
    v_lshrrev_b32 v2, 3, v1
    v_and_b32 v3, 7, v1
    v_lshrrev_b32 v5, 4, v1
    v_and_b32 v5, 1, v5
    v_lshrrev_b32 v6, 1, v3
    v_xor_b32 v6, v6, v5
    v_and_b32 v7, 1, v3
    s_mul_i32 s40, s24, 6
    s_add_u32 s41, s40, 0
    s_lshr_b32 s42, s41, 3
    s_and_b32 s43, s41, 7
    s_lshl_b32 s43, s43, 3
    s_and_b32 s45, s41, 1
    s_lshl_b32 s45, s45, 1
    v_xor_b32 v8, s45, v6
    v_lshlrev_b32 v8, 5, v8
    v_lshl_add_u32 v8, v7, 4, v8
    v_add_u32 v9, s43, v2
    v_mul_u32_u24 v9, 6144, v9
    s_lshl_b32 s46, s42, 11
    s_lshl_b32 s47, s28, 7
    s_add_u32 s46, s46, s47
    v_add_u32 v9, v9, v8
    v_add_u32 v224, s46, v9
    s_add_u32 s41, s40, 1
    s_lshr_b32 s42, s41, 3
    s_and_b32 s43, s41, 7
    s_lshl_b32 s43, s43, 3
    s_and_b32 s45, s41, 1
    s_lshl_b32 s45, s45, 1
    v_xor_b32 v8, s45, v6
    v_lshlrev_b32 v8, 5, v8
    v_lshl_add_u32 v8, v7, 4, v8
    v_add_u32 v9, s43, v2
    v_mul_u32_u24 v9, 6144, v9
    s_lshl_b32 s46, s42, 11
    s_lshl_b32 s47, s28, 7
    s_add_u32 s46, s46, s47
    v_add_u32 v9, v9, v8
    v_add_u32 v225, s46, v9
    s_add_u32 s41, s40, 2
    s_lshr_b32 s42, s41, 3
    s_and_b32 s43, s41, 7
    s_lshl_b32 s43, s43, 3
    s_and_b32 s45, s41, 1
    s_lshl_b32 s45, s45, 1
    v_xor_b32 v8, s45, v6
    v_lshlrev_b32 v8, 5, v8
    v_lshl_add_u32 v8, v7, 4, v8
    v_add_u32 v9, s43, v2
    v_mul_u32_u24 v9, 6144, v9
    s_lshl_b32 s46, s42, 11
    s_lshl_b32 s47, s28, 7
    s_add_u32 s46, s46, s47
    v_add_u32 v9, v9, v8
    v_add_u32 v226, s46, v9
    s_add_u32 s41, s40, 3
    s_lshr_b32 s42, s41, 3
    s_and_b32 s43, s41, 7
    s_lshl_b32 s43, s43, 3
    s_and_b32 s45, s41, 1
    s_lshl_b32 s45, s45, 1
    v_xor_b32 v8, s45, v6
    v_lshlrev_b32 v8, 5, v8
    v_lshl_add_u32 v8, v7, 4, v8
    v_add_u32 v9, s43, v2
    v_mul_u32_u24 v9, 6144, v9
    s_lshl_b32 s46, s42, 11
    s_lshl_b32 s47, s28, 7
    s_add_u32 s46, s46, s47
    v_add_u32 v9, v9, v8
    v_add_u32 v227, s46, v9
    s_add_u32 s41, s40, 4
    s_lshr_b32 s42, s41, 3
    s_and_b32 s43, s41, 7
    s_lshl_b32 s43, s43, 3
    s_and_b32 s45, s41, 1
    s_lshl_b32 s45, s45, 1
    v_xor_b32 v8, s45, v6
    v_lshlrev_b32 v8, 5, v8
    v_lshl_add_u32 v8, v7, 4, v8
    v_add_u32 v9, s43, v2
    v_mul_u32_u24 v9, 6144, v9
    s_lshl_b32 s46, s42, 11
    s_lshl_b32 s47, s28, 7
    s_add_u32 s46, s46, s47
    v_add_u32 v9, v9, v8
    v_add_u32 v228, s46, v9
    s_add_u32 s41, s40, 5
    s_lshr_b32 s42, s41, 3
    s_and_b32 s43, s41, 7
    s_lshl_b32 s43, s43, 3
    s_and_b32 s45, s41, 1
    s_lshl_b32 s45, s45, 1
    v_xor_b32 v8, s45, v6
    v_lshlrev_b32 v8, 5, v8
    v_lshl_add_u32 v8, v7, 4, v8
    v_add_u32 v9, s43, v2
    v_mul_u32_u24 v9, 6144, v9
    s_lshl_b32 s46, s42, 11
    s_lshl_b32 s47, s28, 7
    s_add_u32 s46, s46, s47
    v_add_u32 v9, v9, v8
    v_add_u32 v229, s46, v9
    s_lshl_b32 s30, s24, 12
    s_mul_i32 s31, s24, 6144
    s_add_u32 s31, s31, 16384
    s_mov_b32 s20, 0
    s_mov_b32 s21, 0
    s_mov_b32 s23, 0
    s_add_u32 m0, s23, s30
    s_nop 0
    buffer_load_dwordx4 v220, s[8:11], s20 offen lds
    s_add_u32 m0, m0, 1024
    s_nop 0
    buffer_load_dwordx4 v221, s[8:11], s20 offen lds
    s_add_u32 m0, m0, 1024
    s_nop 0
    buffer_load_dwordx4 v222, s[8:11], s20 offen lds
    s_add_u32 m0, m0, 1024
    s_nop 0
    buffer_load_dwordx4 v223, s[8:11], s20 offen lds
    s_add_u32 m0, s23, s31
    s_nop 0
    buffer_load_dwordx4 v224, s[12:15], s21 offen lds
    s_add_u32 m0, m0, 1024
    s_nop 0
    buffer_load_dwordx4 v225, s[12:15], s21 offen lds
    s_add_u32 m0, m0, 1024
    s_nop 0
    buffer_load_dwordx4 v226, s[12:15], s21 offen lds
    s_add_u32 m0, m0, 1024
    s_nop 0
    buffer_load_dwordx4 v227, s[12:15], s21 offen lds
    s_add_u32 m0, m0, 1024
    s_nop 0
    buffer_load_dwordx4 v228, s[12:15], s21 offen lds
    s_add_u32 m0, m0, 1024
    s_nop 0
    buffer_load_dwordx4 v229, s[12:15], s21 offen lds
    s_add_u32 s20, s20, 128
    s_add_u32 s21, s21, 393216
    s_add_u32 s23, s23, 40960
    s_cmp_eq_u32 s23, 122880
    s_cselect_b32 s23, 0, s23
    s_add_u32 m0, s23, s30
    s_nop 0
    buffer_load_dwordx4 v220, s[8:11], s20 offen lds
    s_add_u32 m0, m0, 1024
    s_nop 0
    buffer_load_dwordx4 v221, s[8:11], s20 offen lds
    s_add_u32 m0, m0, 1024
    s_nop 0
    buffer_load_dwordx4 v222, s[8:11], s20 offen lds
    s_add_u32 m0, m0, 1024
    s_nop 0
    buffer_load_dwordx4 v223, s[8:11], s20 offen lds
    s_add_u32 m0, s23, s31
    s_nop 0
    buffer_load_dwordx4 v224, s[12:15], s21 offen lds
    s_add_u32 m0, m0, 1024
    s_nop 0
    buffer_load_dwordx4 v225, s[12:15], s21 offen lds
    s_add_u32 m0, m0, 1024
    s_nop 0
    buffer_load_dwordx4 v226, s[12:15], s21 offen lds
    s_add_u32 m0, m0, 1024
    s_nop 0
    buffer_load_dwordx4 v227, s[12:15], s21 offen lds
    s_add_u32 m0, m0, 1024
    s_nop 0
    buffer_load_dwordx4 v228, s[12:15], s21 offen lds
    s_add_u32 m0, m0, 1024
    s_nop 0
    buffer_load_dwordx4 v229, s[12:15], s21 offen lds
    s_add_u32 s20, s20, 128
    s_add_u32 s21, s21, 393216
    s_add_u32 s23, s23, 40960
    s_cmp_eq_u32 s23, 122880
    s_cselect_b32 s23, 0, s23
    s_add_u32 m0, s23, s30
    s_nop 0
    buffer_load_dwordx4 v220, s[8:11], s20 offen lds
    s_add_u32 m0, m0, 1024
    s_nop 0
    buffer_load_dwordx4 v221, s[8:11], s20 offen lds
    s_add_u32 m0, m0, 1024
    s_nop 0
    buffer_load_dwordx4 v222, s[8:11], s20 offen lds
    s_add_u32 m0, m0, 1024
    s_nop 0
    buffer_load_dwordx4 v223, s[8:11], s20 offen lds
    s_add_u32 m0, s23, s31
    s_nop 0
    buffer_load_dwordx4 v224, s[12:15], s21 offen lds
    s_add_u32 m0, m0, 1024
    s_nop 0
    buffer_load_dwordx4 v225, s[12:15], s21 offen lds
    s_add_u32 m0, m0, 1024
    s_nop 0
    buffer_load_dwordx4 v226, s[12:15], s21 offen lds
    s_add_u32 m0, m0, 1024
    s_nop 0
    buffer_load_dwordx4 v227, s[12:15], s21 offen lds
    s_add_u32 m0, m0, 1024
    s_nop 0
    buffer_load_dwordx4 v228, s[12:15], s21 offen lds
    s_add_u32 m0, m0, 1024
    s_nop 0
    buffer_load_dwordx4 v229, s[12:15], s21 offen lds
    s_add_u32 s20, s20, 128
    s_add_u32 s21, s21, 393216
    s_add_u32 s23, s23, 40960
    s_cmp_eq_u32 s23, 122880
    s_cselect_b32 s23, 0, s23
    s_waitcnt vmcnt(20)
    s_barrier
    s_mov_b32 s22, 13
L_gemm_qkv_kernel_lloop:
    s_waitcnt vmcnt(10)
    s_barrier
    s_add_u32 m0, s23, s30
    s_nop 0
    buffer_load_dwordx4 v220, s[8:11], s20 offen lds
    s_add_u32 m0, m0, 1024
    s_nop 0
    buffer_load_dwordx4 v221, s[8:11], s20 offen lds
    s_add_u32 m0, m0, 1024
    s_nop 0
    buffer_load_dwordx4 v222, s[8:11], s20 offen lds
    s_add_u32 m0, m0, 1024
    s_nop 0
    buffer_load_dwordx4 v223, s[8:11], s20 offen lds
    s_add_u32 m0, s23, s31
    s_nop 0
    buffer_load_dwordx4 v224, s[12:15], s21 offen lds
    s_add_u32 m0, m0, 1024
    s_nop 0
    buffer_load_dwordx4 v225, s[12:15], s21 offen lds
    s_add_u32 m0, m0, 1024
    s_nop 0
    buffer_load_dwordx4 v226, s[12:15], s21 offen lds
    s_add_u32 m0, m0, 1024
    s_nop 0
    buffer_load_dwordx4 v227, s[12:15], s21 offen lds
    s_add_u32 m0, m0, 1024
    s_nop 0
    buffer_load_dwordx4 v228, s[12:15], s21 offen lds
    s_add_u32 m0, m0, 1024
    s_nop 0
    buffer_load_dwordx4 v229, s[12:15], s21 offen lds
    s_add_u32 s20, s20, 128
    s_add_u32 s21, s21, 393216
    s_add_u32 s23, s23, 40960
    s_cmp_eq_u32 s23, 122880
    s_cselect_b32 s23, 0, s23
    s_sub_u32 s22, s22, 1
    s_cmp_lg_u32 s22, 0
    s_cbranch_scc1 L_gemm_qkv_kernel_lloop
    s_waitcnt vmcnt(0)
    s_barrier
    s_waitcnt vmcnt(0)
    s_barrier
    s_endpgm
L_gemm_qkv_kernel_compute:
    v_lshrrev_b32 v4, 4, v1
    v_and_b32 v2, 15, v1
    v_lshrrev_b32 v3, 1, v2
    s_lshl_b32 s40, s25, 13
    v_lshl_add_u32 v5, v2, 7, s40
    v_xor_b32 v6, v4, v3
    v_lshl_add_u32 v232, v6, 4, v5
    v_xor_b32 v6, 4, v6
    v_lshl_add_u32 v233, v6, 4, v5
    v_lshrrev_b32 v5, 2, v2
    v_lshl_add_u32 v6, v4, 3, v5
    v_lshlrev_b32 v6, 7, v6
    v_and_b32 v7, 3, v1
    v_lshl_add_u32 v6, v7, 3, v6
    v_add_u32 v6, 16384, v6
    v_lshrrev_b32 v5, 1, v5
    v_and_b32 v7, 1, v4
    v_lshl_add_u32 v5, v7, 1, v5
    s_lshl_b32 s40, s26, 1
    s_add_u32 s40, s40, 0
    s_and_b32 s41, s40, 3
    s_lshr_b32 s42, s40, 2
    s_lshl_b32 s42, s42, 13
    v_xor_b32 v7, s41, v5
    v_lshl_add_u32 v7, v7, 5, v6
    v_add_u32 v236, s42, v7
    v_mov_b32 v244, v236
    s_lshl_b32 s40, s26, 1
    s_add_u32 s40, s40, 1
    s_and_b32 s41, s40, 3
    s_lshr_b32 s42, s40, 2
    s_lshl_b32 s42, s42, 13
    v_xor_b32 v7, s41, v5
    v_lshl_add_u32 v7, v7, 5, v6
    v_add_u32 v237, s42, v7
    v_mov_b32 v245, v237
    s_lshl_b32 s40, s26, 1
    s_add_u32 s40, s40, 4
    s_and_b32 s41, s40, 3
    s_lshr_b32 s42, s40, 2
    s_lshl_b32 s42, s42, 13
    v_xor_b32 v7, s41, v5
    v_lshl_add_u32 v7, v7, 5, v6
    v_add_u32 v238, s42, v7
    v_mov_b32 v246, v238
    s_lshl_b32 s40, s26, 1
    s_add_u32 s40, s40, 5
    s_and_b32 s41, s40, 3
    s_lshr_b32 s42, s40, 2
    s_lshl_b32 s42, s42, 13
    v_xor_b32 v7, s41, v5
    v_lshl_add_u32 v7, v7, 5, v6
    v_add_u32 v239, s42, v7
    v_mov_b32 v247, v239
    s_lshl_b32 s40, s26, 1
    s_add_u32 s40, s40, 8
    s_and_b32 s41, s40, 3
    s_lshr_b32 s42, s40, 2
    s_lshl_b32 s42, s42, 13
    v_xor_b32 v7, s41, v5
    v_lshl_add_u32 v7, v7, 5, v6
    v_add_u32 v240, s42, v7
    v_mov_b32 v248, v240
    s_lshl_b32 s40, s26, 1
    s_add_u32 s40, s40, 9
    s_and_b32 s41, s40, 3
    s_lshr_b32 s42, s40, 2
    s_lshl_b32 s42, s42, 13
    v_xor_b32 v7, s41, v5
    v_lshl_add_u32 v7, v7, 5, v6
    v_add_u32 v241, s42, v7
    v_mov_b32 v249, v241
    s_mov_b32 s32, 40960
    s_mov_b32 s33, 40960
    s_mov_b32 s34, 4294885376
    v_mov_b32 v16, 0
    v_mov_b32 v17, 0
    v_mov_b32 v18, 0
    v_mov_b32 v19, 0
    v_mov_b32 v20, 0
    v_mov_b32 v21, 0
    v_mov_b32 v22, 0
    v_mov_b32 v23, 0
    v_mov_b32 v24, 0
    v_mov_b32 v25, 0
    v_mov_b32 v26, 0
    v_mov_b32 v27, 0
    v_mov_b32 v28, 0
    v_mov_b32 v29, 0
    v_mov_b32 v30, 0
    v_mov_b32 v31, 0
    v_mov_b32 v32, 0
    v_mov_b32 v33, 0
    v_mov_b32 v34, 0
    v_mov_b32 v35, 0
    v_mov_b32 v36, 0
    v_mov_b32 v37, 0
    v_mov_b32 v38, 0
    v_mov_b32 v39, 0
    v_mov_b32 v40, 0
    v_mov_b32 v41, 0
    v_mov_b32 v42, 0
    v_mov_b32 v43, 0
    v_mov_b32 v44, 0
    v_mov_b32 v45, 0
    v_mov_b32 v46, 0
    v_mov_b32 v47, 0
    v_mov_b32 v48, 0
    v_mov_b32 v49, 0
    v_mov_b32 v50, 0
    v_mov_b32 v51, 0
    v_mov_b32 v52, 0
    v_mov_b32 v53, 0
    v_mov_b32 v54, 0
    v_mov_b32 v55, 0
    v_mov_b32 v56, 0
    v_mov_b32 v57, 0
    v_mov_b32 v58, 0
    v_mov_b32 v59, 0
    v_mov_b32 v60, 0
    v_mov_b32 v61, 0
    v_mov_b32 v62, 0
    v_mov_b32 v63, 0
    v_mov_b32 v64, 0
    v_mov_b32 v65, 0
    v_mov_b32 v66, 0
    v_mov_b32 v67, 0
    v_mov_b32 v68, 0
    v_mov_b32 v69, 0
    v_mov_b32 v70, 0
    v_mov_b32 v71, 0
    v_mov_b32 v72, 0
    v_mov_b32 v73, 0
    v_mov_b32 v74, 0
    v_mov_b32 v75, 0
    v_mov_b32 v76, 0
    v_mov_b32 v77, 0
    v_mov_b32 v78, 0
    v_mov_b32 v79, 0
    v_mov_b32 v80, 0
    v_mov_b32 v81, 0
    v_mov_b32 v82, 0
    v_mov_b32 v83, 0
    v_mov_b32 v84, 0
    v_mov_b32 v85, 0
    v_mov_b32 v86, 0
    v_mov_b32 v87, 0
    v_mov_b32 v88, 0
    v_mov_b32 v89, 0
    v_mov_b32 v90, 0
    v_mov_b32 v91, 0
    v_mov_b32 v92, 0
    v_mov_b32 v93, 0
    v_mov_b32 v94, 0
    v_mov_b32 v95, 0
    v_mov_b32 v96, 0
    v_mov_b32 v97, 0
    v_mov_b32 v98, 0
    v_mov_b32 v99, 0
    v_mov_b32 v100, 0
    v_mov_b32 v101, 0
    v_mov_b32 v102, 0
    v_mov_b32 v103, 0
    v_mov_b32 v104, 0
    v_mov_b32 v105, 0
    v_mov_b32 v106, 0
    v_mov_b32 v107, 0
    v_mov_b32 v108, 0
    v_mov_b32 v109, 0
    v_mov_b32 v110, 0
    v_mov_b32 v111, 0
    s_barrier
    ds_read_b128 v[128:131], v232 offset:0
    ds_read_b128 v[132:135], v232 offset:2048
    ds_read_b128 v[136:139], v232 offset:4096
    ds_read_b128 v[140:143], v232 offset:6144
    ds_read_b64_tr_b16 v[144:145], v236 offset:0
    ds_read_b64_tr_b16 v[146:147], v236 offset:512
    ds_read_b64_tr_b16 v[148:149], v237 offset:0
    ds_read_b64_tr_b16 v[150:151], v237 offset:512
    ds_read_b64_tr_b16 v[152:153], v238 offset:0
    ds_read_b64_tr_b16 v[154:155], v238 offset:512
    ds_read_b64_tr_b16 v[156:157], v239 offset:0
    ds_read_b64_tr_b16 v[158:159], v239 offset:512
    ds_read_b64_tr_b16 v[160:161], v240 offset:0
    ds_read_b64_tr_b16 v[162:163], v240 offset:512
    ds_read_b64_tr_b16 v[164:165], v241 offset:0
    ds_read_b64_tr_b16 v[166:167], v241 offset:512
    v_add_u32 v232, s32, v232
    v_add_u32 v236, s32, v236
    v_add_u32 v237, s32, v237
    v_add_u32 v238, s32, v238
    v_add_u32 v239, s32, v239
    v_add_u32 v240, s32, v240
    v_add_u32 v241, s32, v241
    s_mov_b32 s22, 15
L_gemm_qkv_kernel_loop:
    s_waitcnt lgkmcnt(0)
    v_mfma_f32_16x16x32_bf16 v[16:19], v[144:147], v[128:131], v[16:19]
    ds_read_b128 v[176:179], v233 offset:0
    v_mfma_f32_16x16x32_bf16 v[40:43], v[144:147], v[132:135], v[40:43]
    ds_read_b128 v[180:183], v233 offset:2048
    v_mfma_f32_16x16x32_bf16 v[64:67], v[144:147], v[136:139], v[64:67]
    ds_read_b128 v[184:187], v233 offset:4096
    v_mfma_f32_16x16x32_bf16 v[88:91], v[144:147], v[140:143], v[88:91]
    ds_read_b128 v[188:191], v233 offset:6144
    v_mfma_f32_16x16x32_bf16 v[20:23], v[148:151], v[128:131], v[20:23]
    ds_read_b64_tr_b16 v[192:193], v244 offset:4096
    v_mfma_f32_16x16x32_bf16 v[44:47], v[148:151], v[132:135], v[44:47]
    ds_read_b64_tr_b16 v[194:195], v244 offset:4608
    v_mfma_f32_16x16x32_bf16 v[68:71], v[148:151], v[136:139], v[68:71]
    ds_read_b64_tr_b16 v[196:197], v245 offset:4096
    v_mfma_f32_16x16x32_bf16 v[92:95], v[148:151], v[140:143], v[92:95]
    ds_read_b64_tr_b16 v[198:199], v245 offset:4608
    v_mfma_f32_16x16x32_bf16 v[24:27], v[128:131], v[152:155], v[24:27]
    ds_read_b64_tr_b16 v[200:201], v246 offset:4096
    v_mfma_f32_16x16x32_bf16 v[48:51], v[132:135], v[152:155], v[48:51]
    ds_read_b64_tr_b16 v[202:203], v246 offset:4608
    v_mfma_f32_16x16x32_bf16 v[72:75], v[136:139], v[152:155], v[72:75]
    ds_read_b64_tr_b16 v[204:205], v247 offset:4096
    v_mfma_f32_16x16x32_bf16 v[96:99], v[140:143], v[152:155], v[96:99]
    ds_read_b64_tr_b16 v[206:207], v247 offset:4608
    v_mfma_f32_16x16x32_bf16 v[28:31], v[128:131], v[156:159], v[28:31]
    ds_read_b64_tr_b16 v[208:209], v248 offset:4096
    v_mfma_f32_16x16x32_bf16 v[52:55], v[132:135], v[156:159], v[52:55]
    ds_read_b64_tr_b16 v[210:211], v248 offset:4608
    v_mfma_f32_16x16x32_bf16 v[76:79], v[136:139], v[156:159], v[76:79]
    ds_read_b64_tr_b16 v[212:213], v249 offset:4096
    v_mfma_f32_16x16x32_bf16 v[100:103], v[140:143], v[156:159], v[100:103]
    ds_read_b64_tr_b16 v[214:215], v249 offset:4608
    v_mfma_f32_16x16x32_bf16 v[32:35], v[128:131], v[160:163], v[32:35]
    v_add_u32 v233, s32, v233
    v_mfma_f32_16x16x32_bf16 v[56:59], v[132:135], v[160:163], v[56:59]
    v_add_u32 v244, s32, v244
    v_mfma_f32_16x16x32_bf16 v[80:83], v[136:139], v[160:163], v[80:83]
    v_add_u32 v245, s32, v245
    v_mfma_f32_16x16x32_bf16 v[104:107], v[140:143], v[160:163], v[104:107]
    v_add_u32 v246, s32, v246
    v_mfma_f32_16x16x32_bf16 v[36:39], v[128:131], v[164:167], v[36:39]
    v_add_u32 v247, s32, v247
    v_mfma_f32_16x16x32_bf16 v[60:63], v[132:135], v[164:167], v[60:63]
    v_add_u32 v248, s32, v248
    v_mfma_f32_16x16x32_bf16 v[84:87], v[136:139], v[164:167], v[84:87]
    v_add_u32 v249, s32, v249
    v_mfma_f32_16x16x32_bf16 v[108:111], v[140:143], v[164:167], v[108:111]
    s_waitcnt lgkmcnt(0)
    s_barrier
    v_mfma_f32_16x16x32_bf16 v[16:19], v[192:195], v[176:179], v[16:19]
    ds_read_b128 v[128:131], v232 offset:0
    ds_read_b128 v[132:135], v232 offset:2048
    v_mfma_f32_16x16x32_bf16 v[40:43], v[192:195], v[180:183], v[40:43]
    ds_read_b128 v[136:139], v232 offset:4096
    ds_read_b128 v[140:143], v232 offset:6144
    v_mfma_f32_16x16x32_bf16 v[64:67], v[192:195], v[184:187], v[64:67]
    ds_read_b64_tr_b16 v[144:145], v236 offset:0
    ds_read_b64_tr_b16 v[146:147], v236 offset:512
    v_mfma_f32_16x16x32_bf16 v[88:91], v[192:195], v[188:191], v[88:91]
    ds_read_b64_tr_b16 v[148:149], v237 offset:0
    v_mfma_f32_16x16x32_bf16 v[20:23], v[196:199], v[176:179], v[20:23]
    ds_read_b64_tr_b16 v[150:151], v237 offset:512
    v_mfma_f32_16x16x32_bf16 v[44:47], v[196:199], v[180:183], v[44:47]
    ds_read_b64_tr_b16 v[152:153], v238 offset:0
    v_mfma_f32_16x16x32_bf16 v[68:71], v[196:199], v[184:187], v[68:71]
    ds_read_b64_tr_b16 v[154:155], v238 offset:512
    v_mfma_f32_16x16x32_bf16 v[92:95], v[196:199], v[188:191], v[92:95]
    ds_read_b64_tr_b16 v[156:157], v239 offset:0
    v_mfma_f32_16x16x32_bf16 v[24:27], v[176:179], v[200:203], v[24:27]
    ds_read_b64_tr_b16 v[158:159], v239 offset:512
    v_mfma_f32_16x16x32_bf16 v[48:51], v[180:183], v[200:203], v[48:51]
    ds_read_b64_tr_b16 v[160:161], v240 offset:0
    v_mfma_f32_16x16x32_bf16 v[72:75], v[184:187], v[200:203], v[72:75]
    ds_read_b64_tr_b16 v[162:163], v240 offset:512
    v_mfma_f32_16x16x32_bf16 v[96:99], v[188:191], v[200:203], v[96:99]
    ds_read_b64_tr_b16 v[164:165], v241 offset:0
    v_mfma_f32_16x16x32_bf16 v[28:31], v[176:179], v[204:207], v[28:31]
    ds_read_b64_tr_b16 v[166:167], v241 offset:512
    v_mfma_f32_16x16x32_bf16 v[52:55], v[180:183], v[204:207], v[52:55]
    v_add_u32 v232, s33, v232
    v_mfma_f32_16x16x32_bf16 v[76:79], v[184:187], v[204:207], v[76:79]
    v_add_u32 v236, s33, v236
    v_mfma_f32_16x16x32_bf16 v[100:103], v[188:191], v[204:207], v[100:103]
    v_add_u32 v237, s33, v237
    v_mfma_f32_16x16x32_bf16 v[32:35], v[176:179], v[208:211], v[32:35]
    v_add_u32 v238, s33, v238
    v_mfma_f32_16x16x32_bf16 v[56:59], v[180:183], v[208:211], v[56:59]
    v_add_u32 v239, s33, v239
    v_mfma_f32_16x16x32_bf16 v[80:83], v[184:187], v[208:211], v[80:83]
    v_add_u32 v240, s33, v240
    v_mfma_f32_16x16x32_bf16 v[104:107], v[188:191], v[208:211], v[104:107]
    v_add_u32 v241, s33, v241
    v_mfma_f32_16x16x32_bf16 v[36:39], v[176:179], v[212:215], v[36:39]
    s_mov_b32 s35, s32
    v_mfma_f32_16x16x32_bf16 v[60:63], v[180:183], v[212:215], v[60:63]
    s_mov_b32 s32, s33
    v_mfma_f32_16x16x32_bf16 v[84:87], v[184:187], v[212:215], v[84:87]
    s_mov_b32 s33, s34
    v_mfma_f32_16x16x32_bf16 v[108:111], v[188:191], v[212:215], v[108:111]
    s_mov_b32 s34, s35
    s_sub_u32 s22, s22, 1
    s_cmp_lg_u32 s22, 0
    s_cbranch_scc1 L_gemm_qkv_kernel_loop
    s_waitcnt lgkmcnt(0)
    v_mfma_f32_16x16x32_bf16 v[16:19], v[144:147], v[128:131], v[16:19]
    ds_read_b128 v[176:179], v233 offset:0
    v_mfma_f32_16x16x32_bf16 v[40:43], v[144:147], v[132:135], v[40:43]
    ds_read_b128 v[180:183], v233 offset:2048
    v_mfma_f32_16x16x32_bf16 v[64:67], v[144:147], v[136:139], v[64:67]
    ds_read_b128 v[184:187], v233 offset:4096
    v_mfma_f32_16x16x32_bf16 v[88:91], v[144:147], v[140:143], v[88:91]
    ds_read_b128 v[188:191], v233 offset:6144
    v_mfma_f32_16x16x32_bf16 v[20:23], v[148:151], v[128:131], v[20:23]
    ds_read_b64_tr_b16 v[192:193], v244 offset:4096
    v_mfma_f32_16x16x32_bf16 v[44:47], v[148:151], v[132:135], v[44:47]
    ds_read_b64_tr_b16 v[194:195], v244 offset:4608
    v_mfma_f32_16x16x32_bf16 v[68:71], v[148:151], v[136:139], v[68:71]
    ds_read_b64_tr_b16 v[196:197], v245 offset:4096
    v_mfma_f32_16x16x32_bf16 v[92:95], v[148:151], v[140:143], v[92:95]
    ds_read_b64_tr_b16 v[198:199], v245 offset:4608
    v_mfma_f32_16x16x32_bf16 v[24:27], v[128:131], v[152:155], v[24:27]
    ds_read_b64_tr_b16 v[200:201], v246 offset:4096
    v_mfma_f32_16x16x32_bf16 v[48:51], v[132:135], v[152:155], v[48:51]
    ds_read_b64_tr_b16 v[202:203], v246 offset:4608
    v_mfma_f32_16x16x32_bf16 v[72:75], v[136:139], v[152:155], v[72:75]
    ds_read_b64_tr_b16 v[204:205], v247 offset:4096
    v_mfma_f32_16x16x32_bf16 v[96:99], v[140:143], v[152:155], v[96:99]
    ds_read_b64_tr_b16 v[206:207], v247 offset:4608
    v_mfma_f32_16x16x32_bf16 v[28:31], v[128:131], v[156:159], v[28:31]
    ds_read_b64_tr_b16 v[208:209], v248 offset:4096
    v_mfma_f32_16x16x32_bf16 v[52:55], v[132:135], v[156:159], v[52:55]
    ds_read_b64_tr_b16 v[210:211], v248 offset:4608
    v_mfma_f32_16x16x32_bf16 v[76:79], v[136:139], v[156:159], v[76:79]
    ds_read_b64_tr_b16 v[212:213], v249 offset:4096
    v_mfma_f32_16x16x32_bf16 v[100:103], v[140:143], v[156:159], v[100:103]
    ds_read_b64_tr_b16 v[214:215], v249 offset:4608
    v_mfma_f32_16x16x32_bf16 v[32:35], v[128:131], v[160:163], v[32:35]
    v_add_u32 v233, s32, v233
    v_mfma_f32_16x16x32_bf16 v[56:59], v[132:135], v[160:163], v[56:59]
    v_add_u32 v244, s32, v244
    v_mfma_f32_16x16x32_bf16 v[80:83], v[136:139], v[160:163], v[80:83]
    v_add_u32 v245, s32, v245
    v_mfma_f32_16x16x32_bf16 v[104:107], v[140:143], v[160:163], v[104:107]
    v_add_u32 v246, s32, v246
    v_mfma_f32_16x16x32_bf16 v[36:39], v[128:131], v[164:167], v[36:39]
    v_add_u32 v247, s32, v247
    v_mfma_f32_16x16x32_bf16 v[60:63], v[132:135], v[164:167], v[60:63]
    v_add_u32 v248, s32, v248
    v_mfma_f32_16x16x32_bf16 v[84:87], v[136:139], v[164:167], v[84:87]
    v_add_u32 v249, s32, v249
    v_mfma_f32_16x16x32_bf16 v[108:111], v[140:143], v[164:167], v[108:111]
    s_waitcnt lgkmcnt(0)
    v_mfma_f32_16x16x32_bf16 v[16:19], v[192:195], v[176:179], v[16:19]
    s_mov_b32 s35, s32
    v_mfma_f32_16x16x32_bf16 v[40:43], v[192:195], v[180:183], v[40:43]
    s_mov_b32 s32, s33
    v_mfma_f32_16x16x32_bf16 v[64:67], v[192:195], v[184:187], v[64:67]
    s_mov_b32 s33, s34
    v_mfma_f32_16x16x32_bf16 v[88:91], v[192:195], v[188:191], v[88:91]
    s_mov_b32 s34, s35
    v_mfma_f32_16x16x32_bf16 v[20:23], v[196:199], v[176:179], v[20:23]
    v_mfma_f32_16x16x32_bf16 v[44:47], v[196:199], v[180:183], v[44:47]
    v_mfma_f32_16x16x32_bf16 v[68:71], v[196:199], v[184:187], v[68:71]
    v_mfma_f32_16x16x32_bf16 v[92:95], v[196:199], v[188:191], v[92:95]
    v_mfma_f32_16x16x32_bf16 v[24:27], v[176:179], v[200:203], v[24:27]
    v_mfma_f32_16x16x32_bf16 v[48:51], v[180:183], v[200:203], v[48:51]
    v_mfma_f32_16x16x32_bf16 v[72:75], v[184:187], v[200:203], v[72:75]
    v_mfma_f32_16x16x32_bf16 v[96:99], v[188:191], v[200:203], v[96:99]
    v_mfma_f32_16x16x32_bf16 v[28:31], v[176:179], v[204:207], v[28:31]
    v_mfma_f32_16x16x32_bf16 v[52:55], v[180:183], v[204:207], v[52:55]
    v_mfma_f32_16x16x32_bf16 v[76:79], v[184:187], v[204:207], v[76:79]
    v_mfma_f32_16x16x32_bf16 v[100:103], v[188:191], v[204:207], v[100:103]
    v_mfma_f32_16x16x32_bf16 v[32:35], v[176:179], v[208:211], v[32:35]
    v_mfma_f32_16x16x32_bf16 v[56:59], v[180:183], v[208:211], v[56:59]
    v_mfma_f32_16x16x32_bf16 v[80:83], v[184:187], v[208:211], v[80:83]
    v_mfma_f32_16x16x32_bf16 v[104:107], v[188:191], v[208:211], v[104:107]
    v_mfma_f32_16x16x32_bf16 v[36:39], v[176:179], v[212:215], v[36:39]
    v_mfma_f32_16x16x32_bf16 v[60:63], v[180:183], v[212:215], v[60:63]
    v_mfma_f32_16x16x32_bf16 v[84:87], v[184:187], v[212:215], v[84:87]
    v_mfma_f32_16x16x32_bf16 v[108:111], v[188:191], v[212:215], v[108:111]
    s_nop 7
    s_nop 7
    v_and_b32 v1, 63, v0
    v_and_b32 v2, 15, v1
    v_lshrrev_b32 v4, 4, v1
    s_lshl_b32 s40, s27, 7
    s_lshl_b32 s41, s25, 6
    s_add_u32 s40, s40, s41
    v_add_u32 v3, s40, v2
    s_add_u32 s16, s4, 8388608
    s_addc_u32 s17, s5, 0
    s_mov_b32 s18, 4194304
    s_mov_b32 s19, 0x00020000
    s_add_u32 s52, s4, 50331648
    s_addc_u32 s53, s5, 0
    s_mov_b32 s54, 2162688
    s_mov_b32 s55, 0x00020000
    s_lshl_b32 s42, s28, 1
    s_add_u32 s42, s42, s26
    s_lshl_b32 s40, s42, 6
    v_lshl_add_u32 v5, v4, 3, s40
    v_lshl_add_u32 v6, v3, 11, v5
    s_mov_b32 s44, 32768
    s_mov_b32 s45, 65536
    s_mov_b32 s46, 98304
    v_mul_f32 v8, 0x3fb8aa3b, v16
    v_mul_f32 v9, 0x3fb8aa3b, v17
    v_mul_f32 v10, 0x3fb8aa3b, v18
    v_mul_f32 v11, 0x3fb8aa3b, v19
    v_exp_f32 v8, v8
    v_exp_f32 v9, v9
    v_exp_f32 v10, v10
    v_exp_f32 v11, v11
    v_cmp_lt_f32 vcc, 0, v16
    v_add_f32 v16, 1.0, v16
    s_nop 1
    v_cndmask_b32 v16, v8, v16, vcc
    v_cmp_lt_f32 vcc, 0, v17
    v_add_f32 v17, 1.0, v17
    s_nop 1
    v_cndmask_b32 v17, v9, v17, vcc
    v_cmp_lt_f32 vcc, 0, v18
    v_add_f32 v18, 1.0, v18
    s_nop 1
    v_cndmask_b32 v18, v10, v18, vcc
    v_cmp_lt_f32 vcc, 0, v19
    v_add_f32 v19, 1.0, v19
    s_nop 1
    v_cndmask_b32 v19, v11, v19, vcc
    v_add_f32 v16, 0x358637bd, v16
    v_add_f32 v17, 0x358637bd, v17
    v_add_f32 v18, 0x358637bd, v18
    v_add_f32 v19, 0x358637bd, v19
    v_cvt_pk_bf16_f32 v16, v16, v17
    v_cvt_pk_bf16_f32 v17, v18, v19
    buffer_store_dwordx2 v[16:17], v6, s[16:19], 0 offen offset:0
    v_mul_f32 v8, 0x3fb8aa3b, v20
    v_mul_f32 v9, 0x3fb8aa3b, v21
    v_mul_f32 v10, 0x3fb8aa3b, v22
    v_mul_f32 v11, 0x3fb8aa3b, v23
    v_exp_f32 v8, v8
    v_exp_f32 v9, v9
    v_exp_f32 v10, v10
    v_exp_f32 v11, v11
    v_cmp_lt_f32 vcc, 0, v20
    v_add_f32 v20, 1.0, v20
    s_nop 1
    v_cndmask_b32 v20, v8, v20, vcc
    v_cmp_lt_f32 vcc, 0, v21
    v_add_f32 v21, 1.0, v21
    s_nop 1
    v_cndmask_b32 v21, v9, v21, vcc
    v_cmp_lt_f32 vcc, 0, v22
    v_add_f32 v22, 1.0, v22
    s_nop 1
    v_cndmask_b32 v22, v10, v22, vcc
    v_cmp_lt_f32 vcc, 0, v23
    v_add_f32 v23, 1.0, v23
    s_nop 1
    v_cndmask_b32 v23, v11, v23, vcc
    v_add_f32 v20, 0x358637bd, v20
    v_add_f32 v21, 0x358637bd, v21
    v_add_f32 v22, 0x358637bd, v22
    v_add_f32 v23, 0x358637bd, v23
    v_cvt_pk_bf16_f32 v20, v20, v21
    v_cvt_pk_bf16_f32 v21, v22, v23
    buffer_store_dwordx2 v[20:21], v6, s[16:19], 0 offen offset:32
    v_mul_f32 v8, 0x3fb8aa3b, v40
    v_mul_f32 v9, 0x3fb8aa3b, v41
    v_mul_f32 v10, 0x3fb8aa3b, v42
    v_mul_f32 v11, 0x3fb8aa3b, v43
    v_exp_f32 v8, v8
    v_exp_f32 v9, v9
    v_exp_f32 v10, v10
    v_exp_f32 v11, v11
    v_cmp_lt_f32 vcc, 0, v40
    v_add_f32 v40, 1.0, v40
    s_nop 1
    v_cndmask_b32 v40, v8, v40, vcc
    v_cmp_lt_f32 vcc, 0, v41
    v_add_f32 v41, 1.0, v41
    s_nop 1
    v_cndmask_b32 v41, v9, v41, vcc
    v_cmp_lt_f32 vcc, 0, v42
    v_add_f32 v42, 1.0, v42
    s_nop 1
    v_cndmask_b32 v42, v10, v42, vcc
    v_cmp_lt_f32 vcc, 0, v43
    v_add_f32 v43, 1.0, v43
    s_nop 1
    v_cndmask_b32 v43, v11, v43, vcc
    v_add_f32 v40, 0x358637bd, v40
    v_add_f32 v41, 0x358637bd, v41
    v_add_f32 v42, 0x358637bd, v42
    v_add_f32 v43, 0x358637bd, v43
    v_cvt_pk_bf16_f32 v40, v40, v41
    v_cvt_pk_bf16_f32 v41, v42, v43
    buffer_store_dwordx2 v[40:41], v6, s[16:19], s44 offen offset:0
    v_mul_f32 v8, 0x3fb8aa3b, v44
    v_mul_f32 v9, 0x3fb8aa3b, v45
    v_mul_f32 v10, 0x3fb8aa3b, v46
    v_mul_f32 v11, 0x3fb8aa3b, v47
    v_exp_f32 v8, v8
    v_exp_f32 v9, v9
    v_exp_f32 v10, v10
    v_exp_f32 v11, v11
    v_cmp_lt_f32 vcc, 0, v44
    v_add_f32 v44, 1.0, v44
    s_nop 1
    v_cndmask_b32 v44, v8, v44, vcc
    v_cmp_lt_f32 vcc, 0, v45
    v_add_f32 v45, 1.0, v45
    s_nop 1
    v_cndmask_b32 v45, v9, v45, vcc
    v_cmp_lt_f32 vcc, 0, v46
    v_add_f32 v46, 1.0, v46
    s_nop 1
    v_cndmask_b32 v46, v10, v46, vcc
    v_cmp_lt_f32 vcc, 0, v47
    v_add_f32 v47, 1.0, v47
    s_nop 1
    v_cndmask_b32 v47, v11, v47, vcc
    v_add_f32 v44, 0x358637bd, v44
    v_add_f32 v45, 0x358637bd, v45
    v_add_f32 v46, 0x358637bd, v46
    v_add_f32 v47, 0x358637bd, v47
    v_cvt_pk_bf16_f32 v44, v44, v45
    v_cvt_pk_bf16_f32 v45, v46, v47
    buffer_store_dwordx2 v[44:45], v6, s[16:19], s44 offen offset:32
    v_mul_f32 v8, 0x3fb8aa3b, v64
    v_mul_f32 v9, 0x3fb8aa3b, v65
    v_mul_f32 v10, 0x3fb8aa3b, v66
    v_mul_f32 v11, 0x3fb8aa3b, v67
    v_exp_f32 v8, v8
    v_exp_f32 v9, v9
    v_exp_f32 v10, v10
    v_exp_f32 v11, v11
    v_cmp_lt_f32 vcc, 0, v64
    v_add_f32 v64, 1.0, v64
    s_nop 1
    v_cndmask_b32 v64, v8, v64, vcc
    v_cmp_lt_f32 vcc, 0, v65
    v_add_f32 v65, 1.0, v65
    s_nop 1
    v_cndmask_b32 v65, v9, v65, vcc
    v_cmp_lt_f32 vcc, 0, v66
    v_add_f32 v66, 1.0, v66
    s_nop 1
    v_cndmask_b32 v66, v10, v66, vcc
    v_cmp_lt_f32 vcc, 0, v67
    v_add_f32 v67, 1.0, v67
    s_nop 1
    v_cndmask_b32 v67, v11, v67, vcc
    v_add_f32 v64, 0x358637bd, v64
    v_add_f32 v65, 0x358637bd, v65
    v_add_f32 v66, 0x358637bd, v66
    v_add_f32 v67, 0x358637bd, v67
    v_cvt_pk_bf16_f32 v64, v64, v65
    v_cvt_pk_bf16_f32 v65, v66, v67
    buffer_store_dwordx2 v[64:65], v6, s[16:19], s45 offen offset:0
    v_mul_f32 v8, 0x3fb8aa3b, v68
    v_mul_f32 v9, 0x3fb8aa3b, v69
    v_mul_f32 v10, 0x3fb8aa3b, v70
    v_mul_f32 v11, 0x3fb8aa3b, v71
    v_exp_f32 v8, v8
    v_exp_f32 v9, v9
    v_exp_f32 v10, v10
    v_exp_f32 v11, v11
    v_cmp_lt_f32 vcc, 0, v68
    v_add_f32 v68, 1.0, v68
    s_nop 1
    v_cndmask_b32 v68, v8, v68, vcc
    v_cmp_lt_f32 vcc, 0, v69
    v_add_f32 v69, 1.0, v69
    s_nop 1
    v_cndmask_b32 v69, v9, v69, vcc
    v_cmp_lt_f32 vcc, 0, v70
    v_add_f32 v70, 1.0, v70
    s_nop 1
    v_cndmask_b32 v70, v10, v70, vcc
    v_cmp_lt_f32 vcc, 0, v71
    v_add_f32 v71, 1.0, v71
    s_nop 1
    v_cndmask_b32 v71, v11, v71, vcc
    v_add_f32 v68, 0x358637bd, v68
    v_add_f32 v69, 0x358637bd, v69
    v_add_f32 v70, 0x358637bd, v70
    v_add_f32 v71, 0x358637bd, v71
    v_cvt_pk_bf16_f32 v68, v68, v69
    v_cvt_pk_bf16_f32 v69, v70, v71
    buffer_store_dwordx2 v[68:69], v6, s[16:19], s45 offen offset:32
    v_mul_f32 v8, 0x3fb8aa3b, v88
    v_mul_f32 v9, 0x3fb8aa3b, v89
    v_mul_f32 v10, 0x3fb8aa3b, v90
    v_mul_f32 v11, 0x3fb8aa3b, v91
    v_exp_f32 v8, v8
    v_exp_f32 v9, v9
    v_exp_f32 v10, v10
    v_exp_f32 v11, v11
    v_cmp_lt_f32 vcc, 0, v88
    v_add_f32 v88, 1.0, v88
    s_nop 1
    v_cndmask_b32 v88, v8, v88, vcc
    v_cmp_lt_f32 vcc, 0, v89
    v_add_f32 v89, 1.0, v89
    s_nop 1
    v_cndmask_b32 v89, v9, v89, vcc
    v_cmp_lt_f32 vcc, 0, v90
    v_add_f32 v90, 1.0, v90
    s_nop 1
    v_cndmask_b32 v90, v10, v90, vcc
    v_cmp_lt_f32 vcc, 0, v91
    v_add_f32 v91, 1.0, v91
    s_nop 1
    v_cndmask_b32 v91, v11, v91, vcc
    v_add_f32 v88, 0x358637bd, v88
    v_add_f32 v89, 0x358637bd, v89
    v_add_f32 v90, 0x358637bd, v90
    v_add_f32 v91, 0x358637bd, v91
    v_cvt_pk_bf16_f32 v88, v88, v89
    v_cvt_pk_bf16_f32 v89, v90, v91
    buffer_store_dwordx2 v[88:89], v6, s[16:19], s46 offen offset:0
    v_mul_f32 v8, 0x3fb8aa3b, v92
    v_mul_f32 v9, 0x3fb8aa3b, v93
    v_mul_f32 v10, 0x3fb8aa3b, v94
    v_mul_f32 v11, 0x3fb8aa3b, v95
    v_exp_f32 v8, v8
    v_exp_f32 v9, v9
    v_exp_f32 v10, v10
    v_exp_f32 v11, v11
    v_cmp_lt_f32 vcc, 0, v92
    v_add_f32 v92, 1.0, v92
    s_nop 1
    v_cndmask_b32 v92, v8, v92, vcc
    v_cmp_lt_f32 vcc, 0, v93
    v_add_f32 v93, 1.0, v93
    s_nop 1
    v_cndmask_b32 v93, v9, v93, vcc
    v_cmp_lt_f32 vcc, 0, v94
    v_add_f32 v94, 1.0, v94
    s_nop 1
    v_cndmask_b32 v94, v10, v94, vcc
    v_cmp_lt_f32 vcc, 0, v95
    v_add_f32 v95, 1.0, v95
    s_nop 1
    v_cndmask_b32 v95, v11, v95, vcc
    v_add_f32 v92, 0x358637bd, v92
    v_add_f32 v93, 0x358637bd, v93
    v_add_f32 v94, 0x358637bd, v94
    v_add_f32 v95, 0x358637bd, v95
    v_cvt_pk_bf16_f32 v92, v92, v93
    v_cvt_pk_bf16_f32 v93, v94, v95
    buffer_store_dwordx2 v[92:93], v6, s[16:19], s46 offen offset:32
    v_mul_f32 v8, 0x3fb8aa3b, v24
    v_mul_f32 v9, 0x3fb8aa3b, v25
    v_mul_f32 v10, 0x3fb8aa3b, v26
    v_mul_f32 v11, 0x3fb8aa3b, v27
    v_exp_f32 v8, v8
    v_exp_f32 v9, v9
    v_exp_f32 v10, v10
    v_exp_f32 v11, v11
    v_cmp_lt_f32 vcc, 0, v24
    v_add_f32 v24, 1.0, v24
    s_nop 1
    v_cndmask_b32 v24, v8, v24, vcc
    v_cmp_lt_f32 vcc, 0, v25
    v_add_f32 v25, 1.0, v25
    s_nop 1
    v_cndmask_b32 v25, v9, v25, vcc
    v_cmp_lt_f32 vcc, 0, v26
    v_add_f32 v26, 1.0, v26
    s_nop 1
    v_cndmask_b32 v26, v10, v26, vcc
    v_cmp_lt_f32 vcc, 0, v27
    v_add_f32 v27, 1.0, v27
    s_nop 1
    v_cndmask_b32 v27, v11, v27, vcc
    v_add_f32 v24, 0x358637bd, v24
    v_add_f32 v25, 0x358637bd, v25
    v_add_f32 v26, 0x358637bd, v26
    v_add_f32 v27, 0x358637bd, v27
    v_cvt_pk_bf16_f32 v128, v24, v25
    v_cvt_pk_bf16_f32 v129, v26, v27
    v_mul_f32 v8, 0x3fb8aa3b, v48
    v_mul_f32 v9, 0x3fb8aa3b, v49
    v_mul_f32 v10, 0x3fb8aa3b, v50
    v_mul_f32 v11, 0x3fb8aa3b, v51
    v_exp_f32 v8, v8
    v_exp_f32 v9, v9
    v_exp_f32 v10, v10
    v_exp_f32 v11, v11
    v_cmp_lt_f32 vcc, 0, v48
    v_add_f32 v48, 1.0, v48
    s_nop 1
    v_cndmask_b32 v48, v8, v48, vcc
    v_cmp_lt_f32 vcc, 0, v49
    v_add_f32 v49, 1.0, v49
    s_nop 1
    v_cndmask_b32 v49, v9, v49, vcc
    v_cmp_lt_f32 vcc, 0, v50
    v_add_f32 v50, 1.0, v50
    s_nop 1
    v_cndmask_b32 v50, v10, v50, vcc
    v_cmp_lt_f32 vcc, 0, v51
    v_add_f32 v51, 1.0, v51
    s_nop 1
    v_cndmask_b32 v51, v11, v51, vcc
    v_add_f32 v48, 0x358637bd, v48
    v_add_f32 v49, 0x358637bd, v49
    v_add_f32 v50, 0x358637bd, v50
    v_add_f32 v51, 0x358637bd, v51
    v_cvt_pk_bf16_f32 v130, v48, v49
    v_cvt_pk_bf16_f32 v131, v50, v51
    v_mul_f32 v8, 0x3fb8aa3b, v72
    v_mul_f32 v9, 0x3fb8aa3b, v73
    v_mul_f32 v10, 0x3fb8aa3b, v74
    v_mul_f32 v11, 0x3fb8aa3b, v75
    v_exp_f32 v8, v8
    v_exp_f32 v9, v9
    v_exp_f32 v10, v10
    v_exp_f32 v11, v11
    v_cmp_lt_f32 vcc, 0, v72
    v_add_f32 v72, 1.0, v72
    s_nop 1
    v_cndmask_b32 v72, v8, v72, vcc
    v_cmp_lt_f32 vcc, 0, v73
    v_add_f32 v73, 1.0, v73
    s_nop 1
    v_cndmask_b32 v73, v9, v73, vcc
    v_cmp_lt_f32 vcc, 0, v74
    v_add_f32 v74, 1.0, v74
    s_nop 1
    v_cndmask_b32 v74, v10, v74, vcc
    v_cmp_lt_f32 vcc, 0, v75
    v_add_f32 v75, 1.0, v75
    s_nop 1
    v_cndmask_b32 v75, v11, v75, vcc
    v_add_f32 v72, 0x358637bd, v72
    v_add_f32 v73, 0x358637bd, v73
    v_add_f32 v74, 0x358637bd, v74
    v_add_f32 v75, 0x358637bd, v75
    v_cvt_pk_bf16_f32 v132, v72, v73
    v_cvt_pk_bf16_f32 v133, v74, v75
    v_mul_f32 v8, 0x3fb8aa3b, v96
    v_mul_f32 v9, 0x3fb8aa3b, v97
    v_mul_f32 v10, 0x3fb8aa3b, v98
    v_mul_f32 v11, 0x3fb8aa3b, v99
    v_exp_f32 v8, v8
    v_exp_f32 v9, v9
    v_exp_f32 v10, v10
    v_exp_f32 v11, v11
    v_cmp_lt_f32 vcc, 0, v96
    v_add_f32 v96, 1.0, v96
    s_nop 1
    v_cndmask_b32 v96, v8, v96, vcc
    v_cmp_lt_f32 vcc, 0, v97
    v_add_f32 v97, 1.0, v97
    s_nop 1
    v_cndmask_b32 v97, v9, v97, vcc
    v_cmp_lt_f32 vcc, 0, v98
    v_add_f32 v98, 1.0, v98
    s_nop 1
    v_cndmask_b32 v98, v10, v98, vcc
    v_cmp_lt_f32 vcc, 0, v99
    v_add_f32 v99, 1.0, v99
    s_nop 1
    v_cndmask_b32 v99, v11, v99, vcc
    v_add_f32 v96, 0x358637bd, v96
    v_add_f32 v97, 0x358637bd, v97
    v_add_f32 v98, 0x358637bd, v98
    v_add_f32 v99, 0x358637bd, v99
    v_cvt_pk_bf16_f32 v134, v96, v97
    v_cvt_pk_bf16_f32 v135, v98, v99
    v_mul_f32 v8, 0x3fb8aa3b, v28
    v_mul_f32 v9, 0x3fb8aa3b, v29
    v_mul_f32 v10, 0x3fb8aa3b, v30
    v_mul_f32 v11, 0x3fb8aa3b, v31
    v_exp_f32 v8, v8
    v_exp_f32 v9, v9
    v_exp_f32 v10, v10
    v_exp_f32 v11, v11
    v_cmp_lt_f32 vcc, 0, v28
    v_add_f32 v28, 1.0, v28
    s_nop 1
    v_cndmask_b32 v28, v8, v28, vcc
    v_cmp_lt_f32 vcc, 0, v29
    v_add_f32 v29, 1.0, v29
    s_nop 1
    v_cndmask_b32 v29, v9, v29, vcc
    v_cmp_lt_f32 vcc, 0, v30
    v_add_f32 v30, 1.0, v30
    s_nop 1
    v_cndmask_b32 v30, v10, v30, vcc
    v_cmp_lt_f32 vcc, 0, v31
    v_add_f32 v31, 1.0, v31
    s_nop 1
    v_cndmask_b32 v31, v11, v31, vcc
    v_add_f32 v28, 0x358637bd, v28
    v_add_f32 v29, 0x358637bd, v29
    v_add_f32 v30, 0x358637bd, v30
    v_add_f32 v31, 0x358637bd, v31
    v_cvt_pk_bf16_f32 v136, v28, v29
    v_cvt_pk_bf16_f32 v137, v30, v31
    v_mul_f32 v8, 0x3fb8aa3b, v52
    v_mul_f32 v9, 0x3fb8aa3b, v53
    v_mul_f32 v10, 0x3fb8aa3b, v54
    v_mul_f32 v11, 0x3fb8aa3b, v55
    v_exp_f32 v8, v8
    v_exp_f32 v9, v9
    v_exp_f32 v10, v10
    v_exp_f32 v11, v11
    v_cmp_lt_f32 vcc, 0, v52
    v_add_f32 v52, 1.0, v52
    s_nop 1
    v_cndmask_b32 v52, v8, v52, vcc
    v_cmp_lt_f32 vcc, 0, v53
    v_add_f32 v53, 1.0, v53
    s_nop 1
    v_cndmask_b32 v53, v9, v53, vcc
    v_cmp_lt_f32 vcc, 0, v54
    v_add_f32 v54, 1.0, v54
    s_nop 1
    v_cndmask_b32 v54, v10, v54, vcc
    v_cmp_lt_f32 vcc, 0, v55
    v_add_f32 v55, 1.0, v55
    s_nop 1
    v_cndmask_b32 v55, v11, v55, vcc
    v_add_f32 v52, 0x358637bd, v52
    v_add_f32 v53, 0x358637bd, v53
    v_add_f32 v54, 0x358637bd, v54
    v_add_f32 v55, 0x358637bd, v55
    v_cvt_pk_bf16_f32 v138, v52, v53
    v_cvt_pk_bf16_f32 v139, v54, v55
    v_mul_f32 v8, 0x3fb8aa3b, v76
    v_mul_f32 v9, 0x3fb8aa3b, v77
    v_mul_f32 v10, 0x3fb8aa3b, v78
    v_mul_f32 v11, 0x3fb8aa3b, v79
    v_exp_f32 v8, v8
    v_exp_f32 v9, v9
    v_exp_f32 v10, v10
    v_exp_f32 v11, v11
    v_cmp_lt_f32 vcc, 0, v76
    v_add_f32 v76, 1.0, v76
    s_nop 1
    v_cndmask_b32 v76, v8, v76, vcc
    v_cmp_lt_f32 vcc, 0, v77
    v_add_f32 v77, 1.0, v77
    s_nop 1
    v_cndmask_b32 v77, v9, v77, vcc
    v_cmp_lt_f32 vcc, 0, v78
    v_add_f32 v78, 1.0, v78
    s_nop 1
    v_cndmask_b32 v78, v10, v78, vcc
    v_cmp_lt_f32 vcc, 0, v79
    v_add_f32 v79, 1.0, v79
    s_nop 1
    v_cndmask_b32 v79, v11, v79, vcc
    v_add_f32 v76, 0x358637bd, v76
    v_add_f32 v77, 0x358637bd, v77
    v_add_f32 v78, 0x358637bd, v78
    v_add_f32 v79, 0x358637bd, v79
    v_cvt_pk_bf16_f32 v140, v76, v77
    v_cvt_pk_bf16_f32 v141, v78, v79
    v_mul_f32 v8, 0x3fb8aa3b, v100
    v_mul_f32 v9, 0x3fb8aa3b, v101
    v_mul_f32 v10, 0x3fb8aa3b, v102
    v_mul_f32 v11, 0x3fb8aa3b, v103
    v_exp_f32 v8, v8
    v_exp_f32 v9, v9
    v_exp_f32 v10, v10
    v_exp_f32 v11, v11
    v_cmp_lt_f32 vcc, 0, v100
    v_add_f32 v100, 1.0, v100
    s_nop 1
    v_cndmask_b32 v100, v8, v100, vcc
    v_cmp_lt_f32 vcc, 0, v101
    v_add_f32 v101, 1.0, v101
    s_nop 1
    v_cndmask_b32 v101, v9, v101, vcc
    v_cmp_lt_f32 vcc, 0, v102
    v_add_f32 v102, 1.0, v102
    s_nop 1
    v_cndmask_b32 v102, v10, v102, vcc
    v_cmp_lt_f32 vcc, 0, v103
    v_add_f32 v103, 1.0, v103
    s_nop 1
    v_cndmask_b32 v103, v11, v103, vcc
    v_add_f32 v100, 0x358637bd, v100
    v_add_f32 v101, 0x358637bd, v101
    v_add_f32 v102, 0x358637bd, v102
    v_add_f32 v103, 0x358637bd, v103
    v_cvt_pk_bf16_f32 v142, v100, v101
    v_cvt_pk_bf16_f32 v143, v102, v103
    v_cvt_pk_bf16_f32 v144, v32, v33
    v_cvt_pk_bf16_f32 v145, v34, v35
    v_cvt_pk_bf16_f32 v146, v56, v57
    v_cvt_pk_bf16_f32 v147, v58, v59
    v_cvt_pk_bf16_f32 v148, v80, v81
    v_cvt_pk_bf16_f32 v149, v82, v83
    v_cvt_pk_bf16_f32 v150, v104, v105
    v_cvt_pk_bf16_f32 v151, v106, v107
    v_cvt_pk_bf16_f32 v152, v36, v37
    v_cvt_pk_bf16_f32 v153, v38, v39
    v_cvt_pk_bf16_f32 v154, v60, v61
    v_cvt_pk_bf16_f32 v155, v62, v63
    v_cvt_pk_bf16_f32 v156, v84, v85
    v_cvt_pk_bf16_f32 v157, v86, v87
    v_cvt_pk_bf16_f32 v158, v108, v109
    v_cvt_pk_bf16_f32 v159, v110, v111
    v_mov_b32 v176, 0x3f803f80
    v_mov_b32 v177, 0x3f803f80
    v_mov_b32 v178, 0x3f803f80
    v_mov_b32 v179, 0x3f803f80
    s_nop 1
    v_mfma_f32_16x16x32_bf16 v[180:183], v[128:131], v[144:147], 0
    v_mfma_f32_16x16x32_bf16 v[180:183], v[132:135], v[148:151], v[180:183]
    v_mfma_f32_16x16x32_bf16 v[184:187], v[128:131], v[152:155], 0
    v_mfma_f32_16x16x32_bf16 v[184:187], v[132:135], v[156:159], v[184:187]
    v_mfma_f32_16x16x32_bf16 v[196:199], v[128:131], v[176:179], 0
    v_mfma_f32_16x16x32_bf16 v[196:199], v[132:135], v[176:179], v[196:199]
    v_mfma_f32_16x16x32_bf16 v[188:191], v[136:139], v[144:147], 0
    v_mfma_f32_16x16x32_bf16 v[188:191], v[140:143], v[148:151], v[188:191]
    v_mfma_f32_16x16x32_bf16 v[192:195], v[136:139], v[152:155], 0
    v_mfma_f32_16x16x32_bf16 v[192:195], v[140:143], v[156:159], v[192:195]
    v_mfma_f32_16x16x32_bf16 v[200:203], v[136:139], v[176:179], 0
    v_mfma_f32_16x16x32_bf16 v[200:203], v[140:143], v[176:179], v[200:203]
    s_nop 7
    s_nop 7
    s_barrier
    s_lshl_b32 s40, s26, 13
    v_lshlrev_b32 v7, 7, v2
    v_lshl_add_u32 v7, v4, 4, v7
    v_add_u32 v7, s40, v7
    v_lshl_add_u32 v9, v4, 4, s40
    s_cmp_eq_u32 s25, 0
    s_cbranch_scc1 L_gemm_qkv_kernel_rd
    ds_write_b128 v7, v[180:183] offset:0
    ds_write_b128 v7, v[184:187] offset:2048
    ds_write_b128 v9, v[196:199] offset:4096
    ds_write_b128 v7, v[188:191] offset:64
    ds_write_b128 v7, v[192:195] offset:2112
    ds_write_b128 v9, v[200:203] offset:4160
    s_waitcnt lgkmcnt(0)
L_gemm_qkv_kernel_rd:
    s_barrier
    s_cmp_eq_u32 s25, 1
    s_cbranch_scc1 L_gemm_qkv_kernel_end
    ds_read_b128 v[128:131], v7 offset:0
    ds_read_b128 v[132:135], v7 offset:2048
    ds_read_b128 v[144:147], v9 offset:4096
    ds_read_b128 v[136:139], v7 offset:64
    ds_read_b128 v[140:143], v7 offset:2112
    ds_read_b128 v[148:151], v9 offset:4160
    s_waitcnt lgkmcnt(0)
    v_add_f32 v180, v180, v128
    v_add_f32 v181, v181, v129
    v_add_f32 v182, v182, v130
    v_add_f32 v183, v183, v131
    v_add_f32 v184, v184, v132
    v_add_f32 v185, v185, v133
    v_add_f32 v186, v186, v134
    v_add_f32 v187, v187, v135
    v_add_f32 v188, v188, v136
    v_add_f32 v189, v189, v137
    v_add_f32 v190, v190, v138
    v_add_f32 v191, v191, v139
    v_add_f32 v192, v192, v140
    v_add_f32 v193, v193, v141
    v_add_f32 v194, v194, v142
    v_add_f32 v195, v195, v143
    v_add_f32 v196, v196, v144
    v_add_f32 v197, v197, v145
    v_add_f32 v198, v198, v146
    v_add_f32 v199, v199, v147
    v_add_f32 v200, v200, v148
    v_add_f32 v201, v201, v149
    v_add_f32 v202, v202, v150
    v_add_f32 v203, v203, v151
    s_mul_i32 s40, s27, 135168
    s_mul_i32 s41, s42, 4224
    s_add_u32 s40, s40, s41
    v_lshlrev_b32 v7, 7, v2
    v_lshl_add_u32 v7, v4, 4, v7
    v_add_u32 v7, s40, v7
    buffer_store_dwordx4 v[180:183], v7, s[52:55], 0 offen offset:0
    buffer_store_dwordx4 v[184:187], v7, s[52:55], 0 offen offset:2048
    buffer_store_dwordx4 v[188:191], v7, s[52:55], 0 offen offset:64
    buffer_store_dwordx4 v[192:195], v7, s[52:55], 0 offen offset:2112
    v_lshl_add_u32 v9, v4, 4, s40
    v_add_u32 v9, 4096, v9
    v_cmp_eq_u32 vcc, 0, v2
    s_and_saveexec_b64 s[58:59], vcc
    buffer_store_dwordx4 v[196:199], v9, s[52:55], 0 offen offset:0
    buffer_store_dwordx4 v[200:203], v9, s[52:55], 0 offen offset:64
    s_mov_b64 exec, s[58:59]
L_gemm_qkv_kernel_end:
    s_endpgm
.globl gemm_wo_kernel
.p2align 8
.type gemm_wo_kernel,@function
gemm_wo_kernel:
    s_cmp_ge_u32 s2, 256
    s_cbranch_scc1 L_gemm_wo_kernel_end
    s_load_dwordx2 s[4:5], s[0:1], 80
    s_load_dwordx2 s[6:7], s[0:1], 16
    v_and_b32 v1, 63, v0
    v_lshrrev_b32 v2, 6, v0
    s_nop 0
    v_readfirstlane_b32 s24, v2
    s_and_b32 s60, s24, 4
    s_and_b32 s24, s24, 3
    s_and_b32 s25, s24, 1
    s_lshr_b32 s26, s24, 1
    s_and_b32 s40, s2, 7
    s_lshr_b32 s41, s2, 3
    s_and_b32 s42, s40, 1
    s_lshl_b32 s42, s42, 3
    s_and_b32 s43, s41, 7
    s_add_u32 s27, s42, s43
    s_lshr_b32 s42, s40, 1
    s_lshl_b32 s42, s42, 2
    s_lshr_b32 s43, s41, 3
    s_add_u32 s28, s42, s43
    s_waitcnt lgkmcnt(0)
    s_add_u32 s8, s4, 12582912
    s_addc_u32 s9, s5, 0
    s_mov_b32 s10, 4194304
    s_mov_b32 s11, 0x00020000
    s_add_u32 s12, s6, 0
    s_addc_u32 s13, s7, 0
    s_mov_b32 s14, 2097152
    s_mov_b32 s15, 0x00020000
    s_cmp_eq_u32 s60, 0
    s_cbranch_scc1 L_gemm_wo_kernel_compute
    v_lshrrev_b32 v2, 3, v1
    v_and_b32 v3, 7, v1
    v_lshrrev_b32 v4, 4, v1
    s_lshl_b32 s40, s27, 7
    s_lshl_b32 s41, s24, 5
    s_add_u32 s40, s40, s41
    v_xor_b32 v5, v3, v4
    v_add_u32 v6, 0, v2
    v_add_u32 v6, s40, v6
    v_mul_u32_u24 v6, 2048, v6
    v_lshl_add_u32 v220, v5, 4, v6
    v_xor_b32 v5, v3, v4
    v_xor_b32 v5, 4, v5
    v_add_u32 v6, 8, v2
    v_add_u32 v6, s40, v6
    v_mul_u32_u24 v6, 2048, v6
    v_lshl_add_u32 v221, v5, 4, v6
    v_xor_b32 v5, v3, v4
    v_add_u32 v6, 16, v2
    v_add_u32 v6, s40, v6
    v_mul_u32_u24 v6, 2048, v6
    v_lshl_add_u32 v222, v5, 4, v6
    v_xor_b32 v5, v3, v4
    v_xor_b32 v5, 4, v5
    v_add_u32 v6, 24, v2
    v_add_u32 v6, s40, v6
    v_mul_u32_u24 v6, 2048, v6
    v_lshl_add_u32 v223, v5, 4, v6
    v_lshrrev_b32 v2, 3, v1
    v_and_b32 v3, 7, v1
    v_lshrrev_b32 v5, 4, v1
    v_and_b32 v5, 1, v5
    v_lshrrev_b32 v6, 1, v3
    v_xor_b32 v6, v6, v5
    v_and_b32 v7, 1, v3
    s_mul_i32 s40, s24, 2
    s_add_u32 s41, s40, 0
    s_lshr_b32 s42, s41, 3
    s_and_b32 s43, s41, 7
    s_lshl_b32 s43, s43, 3
    s_and_b32 s45, s41, 1
    s_lshl_b32 s45, s45, 1
    v_xor_b32 v8, s45, v6
    v_lshlrev_b32 v8, 5, v8
    v_lshl_add_u32 v8, v7, 4, v8
    v_add_u32 v9, s43, v2
    v_mul_u32_u24 v9, 2048, v9
    s_mul_i32 s46, s28, 128
    s_lshl_b32 s47, s42, 7
    s_add_u32 s46, s46, s47
    v_add_u32 v9, v9, v8
    v_add_u32 v224, s46, v9
    s_add_u32 s41, s40, 1
    s_lshr_b32 s42, s41, 3
    s_and_b32 s43, s41, 7
    s_lshl_b32 s43, s43, 3
    s_and_b32 s45, s41, 1
    s_lshl_b32 s45, s45, 1
    v_xor_b32 v8, s45, v6
    v_lshlrev_b32 v8, 5, v8
    v_lshl_add_u32 v8, v7, 4, v8
    v_add_u32 v9, s43, v2
    v_mul_u32_u24 v9, 2048, v9
    s_mul_i32 s46, s28, 128
    s_lshl_b32 s47, s42, 7
    s_add_u32 s46, s46, s47
    v_add_u32 v9, v9, v8
    v_add_u32 v225, s46, v9
    s_lshl_b32 s30, s24, 12
    s_mul_i32 s31, s24, 2048
    s_add_u32 s31, s31, 16384
    s_mov_b32 s20, 0
    s_mov_b32 s21, 0
    s_mov_b32 s23, 0
    s_add_u32 m0, s23, s30
    s_nop 0
    buffer_load_dwordx4 v220, s[8:11], s20 offen lds
    s_add_u32 m0, m0, 1024
    s_nop 0
    buffer_load_dwordx4 v221, s[8:11], s20 offen lds
    s_add_u32 m0, m0, 1024
    s_nop 0
    buffer_load_dwordx4 v222, s[8:11], s20 offen lds
    s_add_u32 m0, m0, 1024
    s_nop 0
    buffer_load_dwordx4 v223, s[8:11], s20 offen lds
    s_add_u32 m0, s23, s31
    s_nop 0
    buffer_load_dwordx4 v224, s[12:15], s21 offen lds
    s_add_u32 m0, m0, 1024
    s_nop 0
    buffer_load_dwordx4 v225, s[12:15], s21 offen lds
    s_add_u32 s20, s20, 128
    s_add_u32 s21, s21, 131072
    s_add_u32 s23, s23, 24576
    s_cmp_eq_u32 s23, 73728
    s_cselect_b32 s23, 0, s23
    s_add_u32 m0, s23, s30
    s_nop 0
    buffer_load_dwordx4 v220, s[8:11], s20 offen lds
    s_add_u32 m0, m0, 1024
    s_nop 0
    buffer_load_dwordx4 v221, s[8:11], s20 offen lds
    s_add_u32 m0, m0, 1024
    s_nop 0
    buffer_load_dwordx4 v222, s[8:11], s20 offen lds
    s_add_u32 m0, m0, 1024
    s_nop 0
    buffer_load_dwordx4 v223, s[8:11], s20 offen lds
    s_add_u32 m0, s23, s31
    s_nop 0
    buffer_load_dwordx4 v224, s[12:15], s21 offen lds
    s_add_u32 m0, m0, 1024
    s_nop 0
    buffer_load_dwordx4 v225, s[12:15], s21 offen lds
    s_add_u32 s20, s20, 128
    s_add_u32 s21, s21, 131072
    s_add_u32 s23, s23, 24576
    s_cmp_eq_u32 s23, 73728
    s_cselect_b32 s23, 0, s23
    s_add_u32 m0, s23, s30
    s_nop 0
    buffer_load_dwordx4 v220, s[8:11], s20 offen lds
    s_add_u32 m0, m0, 1024
    s_nop 0
    buffer_load_dwordx4 v221, s[8:11], s20 offen lds
    s_add_u32 m0, m0, 1024
    s_nop 0
    buffer_load_dwordx4 v222, s[8:11], s20 offen lds
    s_add_u32 m0, m0, 1024
    s_nop 0
    buffer_load_dwordx4 v223, s[8:11], s20 offen lds
    s_add_u32 m0, s23, s31
    s_nop 0
    buffer_load_dwordx4 v224, s[12:15], s21 offen lds
    s_add_u32 m0, m0, 1024
    s_nop 0
    buffer_load_dwordx4 v225, s[12:15], s21 offen lds
    s_add_u32 s20, s20, 128
    s_add_u32 s21, s21, 131072
    s_add_u32 s23, s23, 24576
    s_cmp_eq_u32 s23, 73728
    s_cselect_b32 s23, 0, s23
    s_waitcnt vmcnt(12)
    s_barrier
    s_mov_b32 s22, 13
L_gemm_wo_kernel_lloop:
    s_waitcnt vmcnt(6)
    s_barrier
    s_add_u32 m0, s23, s30
    s_nop 0
    buffer_load_dwordx4 v220, s[8:11], s20 offen lds
    s_add_u32 m0, m0, 1024
    s_nop 0
    buffer_load_dwordx4 v221, s[8:11], s20 offen lds
    s_add_u32 m0, m0, 1024
    s_nop 0
    buffer_load_dwordx4 v222, s[8:11], s20 offen lds
    s_add_u32 m0, m0, 1024
    s_nop 0
    buffer_load_dwordx4 v223, s[8:11], s20 offen lds
    s_add_u32 m0, s23, s31
    s_nop 0
    buffer_load_dwordx4 v224, s[12:15], s21 offen lds
    s_add_u32 m0, m0, 1024
    s_nop 0
    buffer_load_dwordx4 v225, s[12:15], s21 offen lds
    s_add_u32 s20, s20, 128
    s_add_u32 s21, s21, 131072
    s_add_u32 s23, s23, 24576
    s_cmp_eq_u32 s23, 73728
    s_cselect_b32 s23, 0, s23
    s_sub_u32 s22, s22, 1
    s_cmp_lg_u32 s22, 0
    s_cbranch_scc1 L_gemm_wo_kernel_lloop
    s_waitcnt vmcnt(0)
    s_barrier
    s_waitcnt vmcnt(0)
    s_barrier
    s_endpgm
L_gemm_wo_kernel_compute:
    v_lshrrev_b32 v4, 4, v1
    v_and_b32 v2, 15, v1
    v_lshrrev_b32 v3, 1, v2
    s_lshl_b32 s40, s25, 13
    v_lshl_add_u32 v5, v2, 7, s40
    v_xor_b32 v6, v4, v3
    v_lshl_add_u32 v232, v6, 4, v5
    v_xor_b32 v6, 4, v6
    v_lshl_add_u32 v233, v6, 4, v5
    v_lshrrev_b32 v5, 2, v2
    v_lshl_add_u32 v6, v4, 3, v5
    v_lshlrev_b32 v6, 7, v6
    v_and_b32 v7, 3, v1
    v_lshl_add_u32 v6, v7, 3, v6
    v_add_u32 v6, 16384, v6
    v_lshrrev_b32 v5, 1, v5
    v_and_b32 v7, 1, v4
    v_lshl_add_u32 v5, v7, 1, v5
    s_mul_i32 s40, s26, 2
    s_add_u32 s40, s40, 0
    s_and_b32 s41, s40, 3
    s_lshr_b32 s42, s40, 2
    s_lshl_b32 s42, s42, 13
    v_xor_b32 v7, s41, v5
    v_lshl_add_u32 v7, v7, 5, v6
    v_add_u32 v236, s42, v7
    v_mov_b32 v244, v236
    s_mul_i32 s40, s26, 2
    s_add_u32 s40, s40, 1
    s_and_b32 s41, s40, 3
    s_lshr_b32 s42, s40, 2
    s_lshl_b32 s42, s42, 13
    v_xor_b32 v7, s41, v5
    v_lshl_add_u32 v7, v7, 5, v6
    v_add_u32 v237, s42, v7
    v_mov_b32 v245, v237
    s_mov_b32 s32, 24576
    s_mov_b32 s33, 24576
    s_mov_b32 s34, 4294918144
    v_mov_b32 v16, 0
    v_mov_b32 v17, 0
    v_mov_b32 v18, 0
    v_mov_b32 v19, 0
    v_mov_b32 v20, 0
    v_mov_b32 v21, 0
    v_mov_b32 v22, 0
    v_mov_b32 v23, 0
    v_mov_b32 v24, 0
    v_mov_b32 v25, 0
    v_mov_b32 v26, 0
    v_mov_b32 v27, 0
    v_mov_b32 v28, 0
    v_mov_b32 v29, 0
    v_mov_b32 v30, 0
    v_mov_b32 v31, 0
    v_mov_b32 v32, 0
    v_mov_b32 v33, 0
    v_mov_b32 v34, 0
    v_mov_b32 v35, 0
    v_mov_b32 v36, 0
    v_mov_b32 v37, 0
    v_mov_b32 v38, 0
    v_mov_b32 v39, 0
    v_mov_b32 v40, 0
    v_mov_b32 v41, 0
    v_mov_b32 v42, 0
    v_mov_b32 v43, 0
    v_mov_b32 v44, 0
    v_mov_b32 v45, 0
    v_mov_b32 v46, 0
    v_mov_b32 v47, 0
    s_barrier
    ds_read_b128 v[128:131], v232 offset:0
    ds_read_b128 v[132:135], v232 offset:2048
    ds_read_b128 v[136:139], v232 offset:4096
    ds_read_b128 v[140:143], v232 offset:6144
    ds_read_b64_tr_b16 v[144:145], v236 offset:0
    ds_read_b64_tr_b16 v[146:147], v236 offset:512
    ds_read_b64_tr_b16 v[148:149], v237 offset:0
    ds_read_b64_tr_b16 v[150:151], v237 offset:512
    v_add_u32 v232, s32, v232
    v_add_u32 v236, s32, v236
    v_add_u32 v237, s32, v237
    s_mov_b32 s22, 15
L_gemm_wo_kernel_loop:
    s_waitcnt lgkmcnt(0)
    v_mfma_f32_16x16x32_bf16 v[16:19], v[144:147], v[128:131], v[16:19]
    ds_read_b128 v[176:179], v233 offset:0
    ds_read_b128 v[180:183], v233 offset:2048
    v_mfma_f32_16x16x32_bf16 v[24:27], v[144:147], v[132:135], v[24:27]
    ds_read_b128 v[184:187], v233 offset:4096
    ds_read_b128 v[188:191], v233 offset:6144
    v_mfma_f32_16x16x32_bf16 v[32:35], v[144:147], v[136:139], v[32:35]
    ds_read_b64_tr_b16 v[192:193], v244 offset:4096
    ds_read_b64_tr_b16 v[194:195], v244 offset:4608
    v_mfma_f32_16x16x32_bf16 v[40:43], v[144:147], v[140:143], v[40:43]
    ds_read_b64_tr_b16 v[196:197], v245 offset:4096
    v_mfma_f32_16x16x32_bf16 v[20:23], v[148:151], v[128:131], v[20:23]
    ds_read_b64_tr_b16 v[198:199], v245 offset:4608
    v_mfma_f32_16x16x32_bf16 v[28:31], v[148:151], v[132:135], v[28:31]
    v_add_u32 v233, s32, v233
    v_mfma_f32_16x16x32_bf16 v[36:39], v[148:151], v[136:139], v[36:39]
    v_add_u32 v244, s32, v244
    v_mfma_f32_16x16x32_bf16 v[44:47], v[148:151], v[140:143], v[44:47]
    v_add_u32 v245, s32, v245
    s_waitcnt lgkmcnt(0)
    s_barrier
    v_mfma_f32_16x16x32_bf16 v[16:19], v[192:195], v[176:179], v[16:19]
    ds_read_b128 v[128:131], v232 offset:0
    ds_read_b128 v[132:135], v232 offset:2048
    v_mfma_f32_16x16x32_bf16 v[24:27], v[192:195], v[180:183], v[24:27]
    ds_read_b128 v[136:139], v232 offset:4096
    ds_read_b128 v[140:143], v232 offset:6144
    v_mfma_f32_16x16x32_bf16 v[32:35], v[192:195], v[184:187], v[32:35]
    ds_read_b64_tr_b16 v[144:145], v236 offset:0
    ds_read_b64_tr_b16 v[146:147], v236 offset:512
    v_mfma_f32_16x16x32_bf16 v[40:43], v[192:195], v[188:191], v[40:43]
    ds_read_b64_tr_b16 v[148:149], v237 offset:0
    ds_read_b64_tr_b16 v[150:151], v237 offset:512
    v_mfma_f32_16x16x32_bf16 v[20:23], v[196:199], v[176:179], v[20:23]
    v_add_u32 v232, s33, v232
    v_add_u32 v236, s33, v236
    v_mfma_f32_16x16x32_bf16 v[28:31], v[196:199], v[180:183], v[28:31]
    v_add_u32 v237, s33, v237
    s_mov_b32 s35, s32
    v_mfma_f32_16x16x32_bf16 v[36:39], v[196:199], v[184:187], v[36:39]
    s_mov_b32 s32, s33
    s_mov_b32 s33, s34
    v_mfma_f32_16x16x32_bf16 v[44:47], v[196:199], v[188:191], v[44:47]
    s_mov_b32 s34, s35
    s_sub_u32 s22, s22, 1
    s_cmp_lg_u32 s22, 0
    s_cbranch_scc1 L_gemm_wo_kernel_loop
    s_waitcnt lgkmcnt(0)
    v_mfma_f32_16x16x32_bf16 v[16:19], v[144:147], v[128:131], v[16:19]
    ds_read_b128 v[176:179], v233 offset:0
    ds_read_b128 v[180:183], v233 offset:2048
    v_mfma_f32_16x16x32_bf16 v[24:27], v[144:147], v[132:135], v[24:27]
    ds_read_b128 v[184:187], v233 offset:4096
    ds_read_b128 v[188:191], v233 offset:6144
    v_mfma_f32_16x16x32_bf16 v[32:35], v[144:147], v[136:139], v[32:35]
    ds_read_b64_tr_b16 v[192:193], v244 offset:4096
    ds_read_b64_tr_b16 v[194:195], v244 offset:4608
    v_mfma_f32_16x16x32_bf16 v[40:43], v[144:147], v[140:143], v[40:43]
    ds_read_b64_tr_b16 v[196:197], v245 offset:4096
    v_mfma_f32_16x16x32_bf16 v[20:23], v[148:151], v[128:131], v[20:23]
    ds_read_b64_tr_b16 v[198:199], v245 offset:4608
    v_mfma_f32_16x16x32_bf16 v[28:31], v[148:151], v[132:135], v[28:31]
    v_add_u32 v233, s32, v233
    v_mfma_f32_16x16x32_bf16 v[36:39], v[148:151], v[136:139], v[36:39]
    v_add_u32 v244, s32, v244
    v_mfma_f32_16x16x32_bf16 v[44:47], v[148:151], v[140:143], v[44:47]
    v_add_u32 v245, s32, v245
    s_waitcnt lgkmcnt(0)
    v_mfma_f32_16x16x32_bf16 v[16:19], v[192:195], v[176:179], v[16:19]
    s_mov_b32 s35, s32
    v_mfma_f32_16x16x32_bf16 v[24:27], v[192:195], v[180:183], v[24:27]
    s_mov_b32 s32, s33
    v_mfma_f32_16x16x32_bf16 v[32:35], v[192:195], v[184:187], v[32:35]
    s_mov_b32 s33, s34
    v_mfma_f32_16x16x32_bf16 v[40:43], v[192:195], v[188:191], v[40:43]
    s_mov_b32 s34, s35
    v_mfma_f32_16x16x32_bf16 v[20:23], v[196:199], v[176:179], v[20:23]
    v_mfma_f32_16x16x32_bf16 v[28:31], v[196:199], v[180:183], v[28:31]
    v_mfma_f32_16x16x32_bf16 v[36:39], v[196:199], v[184:187], v[36:39]
    v_mfma_f32_16x16x32_bf16 v[44:47], v[196:199], v[188:191], v[44:47]
    s_nop 7
    s_nop 7
    v_and_b32 v1, 63, v0
    v_and_b32 v2, 15, v1
    v_lshrrev_b32 v4, 4, v1
    s_lshl_b32 s40, s27, 7
    s_lshl_b32 s41, s25, 6
    s_add_u32 s40, s40, s41
    v_add_u32 v3, s40, v2
    s_add_u32 s16, s4, 0
    s_addc_u32 s17, s5, 0
    s_mov_b32 s18, 4194304
    s_mov_b32 s19, 0x00020000
    s_lshl_b32 s40, s28, 7
    s_lshl_b32 s41, s26, 6
    s_add_u32 s40, s40, s41
    v_lshl_add_u32 v5, v4, 3, s40
    v_lshl_add_u32 v6, v3, 11, v5
    s_mov_b32 s44, 32768
    s_mov_b32 s45, 65536
    s_mov_b32 s46, 98304
    buffer_load_dwordx2 v[128:129], v6, s[16:19], 0 offen offset:0
    buffer_load_dwordx2 v[130:131], v6, s[16:19], 0 offen offset:32
    buffer_load_dwordx2 v[132:133], v6, s[16:19], s44 offen offset:0
    buffer_load_dwordx2 v[134:135], v6, s[16:19], s44 offen offset:32
    buffer_load_dwordx2 v[136:137], v6, s[16:19], s45 offen offset:0
    buffer_load_dwordx2 v[138:139], v6, s[16:19], s45 offen offset:32
    buffer_load_dwordx2 v[140:141], v6, s[16:19], s46 offen offset:0
    buffer_load_dwordx2 v[142:143], v6, s[16:19], s46 offen offset:32
    s_waitcnt vmcnt(0)
    v_cvt_pk_bf16_f32 v8, v16, v17
    v_cvt_pk_bf16_f32 v9, v18, v19
    v_lshlrev_b32 v16, 16, v8
    v_and_b32 v17, 0xffff0000, v8
    v_lshlrev_b32 v18, 16, v9
    v_and_b32 v19, 0xffff0000, v9
    v_lshlrev_b32 v8, 16, v128
    v_and_b32 v9, 0xffff0000, v128
    v_lshlrev_b32 v10, 16, v129
    v_and_b32 v11, 0xffff0000, v129
    v_add_f32 v16, v16, v8
    v_add_f32 v17, v17, v9
    v_add_f32 v18, v18, v10
    v_add_f32 v19, v19, v11
    v_cvt_pk_bf16_f32 v16, v16, v17
    v_cvt_pk_bf16_f32 v17, v18, v19
    buffer_store_dwordx2 v[16:17], v6, s[16:19], 0 offen offset:0
    v_cvt_pk_bf16_f32 v8, v20, v21
    v_cvt_pk_bf16_f32 v9, v22, v23
    v_lshlrev_b32 v20, 16, v8
    v_and_b32 v21, 0xffff0000, v8
    v_lshlrev_b32 v22, 16, v9
    v_and_b32 v23, 0xffff0000, v9
    v_lshlrev_b32 v8, 16, v130
    v_and_b32 v9, 0xffff0000, v130
    v_lshlrev_b32 v10, 16, v131
    v_and_b32 v11, 0xffff0000, v131
    v_add_f32 v20, v20, v8
    v_add_f32 v21, v21, v9
    v_add_f32 v22, v22, v10
    v_add_f32 v23, v23, v11
    v_cvt_pk_bf16_f32 v20, v20, v21
    v_cvt_pk_bf16_f32 v21, v22, v23
    buffer_store_dwordx2 v[20:21], v6, s[16:19], 0 offen offset:32
    v_cvt_pk_bf16_f32 v8, v24, v25
    v_cvt_pk_bf16_f32 v9, v26, v27
    v_lshlrev_b32 v24, 16, v8
    v_and_b32 v25, 0xffff0000, v8
    v_lshlrev_b32 v26, 16, v9
    v_and_b32 v27, 0xffff0000, v9
    v_lshlrev_b32 v8, 16, v132
    v_and_b32 v9, 0xffff0000, v132
    v_lshlrev_b32 v10, 16, v133
    v_and_b32 v11, 0xffff0000, v133
    v_add_f32 v24, v24, v8
    v_add_f32 v25, v25, v9
    v_add_f32 v26, v26, v10
    v_add_f32 v27, v27, v11
    v_cvt_pk_bf16_f32 v24, v24, v25
    v_cvt_pk_bf16_f32 v25, v26, v27
    buffer_store_dwordx2 v[24:25], v6, s[16:19], s44 offen offset:0
    v_cvt_pk_bf16_f32 v8, v28, v29
    v_cvt_pk_bf16_f32 v9, v30, v31
    v_lshlrev_b32 v28, 16, v8
    v_and_b32 v29, 0xffff0000, v8
    v_lshlrev_b32 v30, 16, v9
    v_and_b32 v31, 0xffff0000, v9
    v_lshlrev_b32 v8, 16, v134
    v_and_b32 v9, 0xffff0000, v134
    v_lshlrev_b32 v10, 16, v135
    v_and_b32 v11, 0xffff0000, v135
    v_add_f32 v28, v28, v8
    v_add_f32 v29, v29, v9
    v_add_f32 v30, v30, v10
    v_add_f32 v31, v31, v11
    v_cvt_pk_bf16_f32 v28, v28, v29
    v_cvt_pk_bf16_f32 v29, v30, v31
    buffer_store_dwordx2 v[28:29], v6, s[16:19], s44 offen offset:32
    v_cvt_pk_bf16_f32 v8, v32, v33
    v_cvt_pk_bf16_f32 v9, v34, v35
    v_lshlrev_b32 v32, 16, v8
    v_and_b32 v33, 0xffff0000, v8
    v_lshlrev_b32 v34, 16, v9
    v_and_b32 v35, 0xffff0000, v9
    v_lshlrev_b32 v8, 16, v136
    v_and_b32 v9, 0xffff0000, v136
    v_lshlrev_b32 v10, 16, v137
    v_and_b32 v11, 0xffff0000, v137
    v_add_f32 v32, v32, v8
    v_add_f32 v33, v33, v9
    v_add_f32 v34, v34, v10
    v_add_f32 v35, v35, v11
    v_cvt_pk_bf16_f32 v32, v32, v33
    v_cvt_pk_bf16_f32 v33, v34, v35
    buffer_store_dwordx2 v[32:33], v6, s[16:19], s45 offen offset:0
    v_cvt_pk_bf16_f32 v8, v36, v37
    v_cvt_pk_bf16_f32 v9, v38, v39
    v_lshlrev_b32 v36, 16, v8
    v_and_b32 v37, 0xffff0000, v8
    v_lshlrev_b32 v38, 16, v9
    v_and_b32 v39, 0xffff0000, v9
    v_lshlrev_b32 v8, 16, v138
    v_and_b32 v9, 0xffff0000, v138
    v_lshlrev_b32 v10, 16, v139
    v_and_b32 v11, 0xffff0000, v139
    v_add_f32 v36, v36, v8
    v_add_f32 v37, v37, v9
    v_add_f32 v38, v38, v10
    v_add_f32 v39, v39, v11
    v_cvt_pk_bf16_f32 v36, v36, v37
    v_cvt_pk_bf16_f32 v37, v38, v39
    buffer_store_dwordx2 v[36:37], v6, s[16:19], s45 offen offset:32
    v_cvt_pk_bf16_f32 v8, v40, v41
    v_cvt_pk_bf16_f32 v9, v42, v43
    v_lshlrev_b32 v40, 16, v8
    v_and_b32 v41, 0xffff0000, v8
    v_lshlrev_b32 v42, 16, v9
    v_and_b32 v43, 0xffff0000, v9
    v_lshlrev_b32 v8, 16, v140
    v_and_b32 v9, 0xffff0000, v140
    v_lshlrev_b32 v10, 16, v141
    v_and_b32 v11, 0xffff0000, v141
    v_add_f32 v40, v40, v8
    v_add_f32 v41, v41, v9
    v_add_f32 v42, v42, v10
    v_add_f32 v43, v43, v11
    v_cvt_pk_bf16_f32 v40, v40, v41
    v_cvt_pk_bf16_f32 v41, v42, v43
    buffer_store_dwordx2 v[40:41], v6, s[16:19], s46 offen offset:0
    v_cvt_pk_bf16_f32 v8, v44, v45
    v_cvt_pk_bf16_f32 v9, v46, v47
    v_lshlrev_b32 v44, 16, v8
    v_and_b32 v45, 0xffff0000, v8
    v_lshlrev_b32 v46, 16, v9
    v_and_b32 v47, 0xffff0000, v9
    v_lshlrev_b32 v8, 16, v142
    v_and_b32 v9, 0xffff0000, v142
    v_lshlrev_b32 v10, 16, v143
    v_and_b32 v11, 0xffff0000, v143
    v_add_f32 v44, v44, v8
    v_add_f32 v45, v45, v9
    v_add_f32 v46, v46, v10
    v_add_f32 v47, v47, v11
    v_cvt_pk_bf16_f32 v44, v44, v45
    v_cvt_pk_bf16_f32 v45, v46, v47
    buffer_store_dwordx2 v[44:45], v6, s[16:19], s46 offen offset:32
L_gemm_wo_kernel_end:
    s_endpgm
.globl gemm_w1_kernel
.p2align 8
.type gemm_w1_kernel,@function
gemm_w1_kernel:
    s_cmp_ge_u32 s2, 256
    s_cbranch_scc1 L_gemm_w1_kernel_end
    s_load_dwordx2 s[4:5], s[0:1], 80
    s_load_dwordx2 s[6:7], s[0:1], 32
    s_load_dwordx2 s[50:51], s[0:1], 40
    v_and_b32 v1, 63, v0
    v_lshrrev_b32 v2, 6, v0
    s_nop 0
    v_readfirstlane_b32 s24, v2
    s_and_b32 s60, s24, 4
    s_and_b32 s24, s24, 3
    s_and_b32 s25, s24, 1
    s_lshr_b32 s26, s24, 1
    s_and_b32 s40, s2, 7
    s_lshr_b32 s41, s2, 3
    s_and_b32 s42, s40, 1
    s_lshl_b32 s42, s42, 3
    s_and_b32 s43, s41, 7
    s_add_u32 s27, s42, s43
    s_lshr_b32 s42, s40, 1
    s_lshl_b32 s42, s42, 2
    s_lshr_b32 s43, s41, 3
    s_add_u32 s28, s42, s43
    s_waitcnt lgkmcnt(0)
    s_add_u32 s8, s4, 4194304
    s_addc_u32 s9, s5, 0
    s_mov_b32 s10, 4194304
    s_mov_b32 s11, 0x00020000
    s_add_u32 s12, s6, 0
    s_addc_u32 s13, s7, 0
    s_mov_b32 s14, 7340032
    s_mov_b32 s15, 0x00020000
    s_cmp_eq_u32 s60, 0
    s_cbranch_scc1 L_gemm_w1_kernel_compute
    v_lshrrev_b32 v2, 3, v1
    v_and_b32 v3, 7, v1
    v_lshrrev_b32 v4, 4, v1
    s_lshl_b32 s40, s27, 7
    s_lshl_b32 s41, s24, 5
    s_add_u32 s40, s40, s41
    v_xor_b32 v5, v3, v4
    v_add_u32 v6, 0, v2
    v_add_u32 v6, s40, v6
    v_mul_u32_u24 v6, 2048, v6
    v_lshl_add_u32 v220, v5, 4, v6
    v_xor_b32 v5, v3, v4
    v_xor_b32 v5, 4, v5
    v_add_u32 v6, 8, v2
    v_add_u32 v6, s40, v6
    v_mul_u32_u24 v6, 2048, v6
    v_lshl_add_u32 v221, v5, 4, v6
    v_xor_b32 v5, v3, v4
    v_add_u32 v6, 16, v2
    v_add_u32 v6, s40, v6
    v_mul_u32_u24 v6, 2048, v6
    v_lshl_add_u32 v222, v5, 4, v6
    v_xor_b32 v5, v3, v4
    v_xor_b32 v5, 4, v5
    v_add_u32 v6, 24, v2
    v_add_u32 v6, s40, v6
    v_mul_u32_u24 v6, 2048, v6
    v_lshl_add_u32 v223, v5, 4, v6
    v_lshrrev_b32 v2, 3, v1
    v_and_b32 v3, 7, v1
    v_lshrrev_b32 v5, 4, v1
    v_and_b32 v5, 1, v5
    v_lshrrev_b32 v6, 1, v3
    v_xor_b32 v6, v6, v5
    v_and_b32 v7, 1, v3
    s_mul_i32 s40, s24, 8
    s_add_u32 s41, s40, 0
    s_lshr_b32 s42, s41, 3
    s_and_b32 s43, s41, 7
    s_lshl_b32 s43, s43, 3
    s_and_b32 s45, s41, 1
    s_lshl_b32 s45, s45, 1
    v_xor_b32 v8, s45, v6
    v_lshlrev_b32 v8, 5, v8
    v_lshl_add_u32 v8, v7, 4, v8
    v_add_u32 v9, s43, v2
    v_mul_u32_u24 v9, 7168, v9
    s_mul_i32 s46, s28, 448
    s_lshl_b32 s47, s42, 7
    s_add_u32 s46, s46, s47
    v_add_u32 v9, v9, v8
    v_add_u32 v224, s46, v9
    s_add_u32 s41, s40, 1
    s_lshr_b32 s42, s41, 3
    s_and_b32 s43, s41, 7
    s_lshl_b32 s43, s43, 3
    s_and_b32 s45, s41, 1
    s_lshl_b32 s45, s45, 1
    v_xor_b32 v8, s45, v6
    v_lshlrev_b32 v8, 5, v8
    v_lshl_add_u32 v8, v7, 4, v8
    v_add_u32 v9, s43, v2
    v_mul_u32_u24 v9, 7168, v9
    s_mul_i32 s46, s28, 448
    s_lshl_b32 s47, s42, 7
    s_add_u32 s46, s46, s47
    v_add_u32 v9, v9, v8
    v_add_u32 v225, s46, v9
    s_add_u32 s41, s40, 2
    s_lshr_b32 s42, s41, 3
    s_and_b32 s43, s41, 7
    s_lshl_b32 s43, s43, 3
    s_and_b32 s45, s41, 1
    s_lshl_b32 s45, s45, 1
    v_xor_b32 v8, s45, v6
    v_lshlrev_b32 v8, 5, v8
    v_lshl_add_u32 v8, v7, 4, v8
    v_add_u32 v9, s43, v2
    v_mul_u32_u24 v9, 7168, v9
    s_mul_i32 s46, s28, 448
    s_lshl_b32 s47, s42, 7
    s_add_u32 s46, s46, s47
    v_add_u32 v9, v9, v8
    v_add_u32 v226, s46, v9
    s_add_u32 s41, s40, 3
    s_lshr_b32 s42, s41, 3
    s_and_b32 s43, s41, 7
    s_lshl_b32 s43, s43, 3
    s_and_b32 s45, s41, 1
    s_lshl_b32 s45, s45, 1
    v_xor_b32 v8, s45, v6
    v_lshlrev_b32 v8, 5, v8
    v_lshl_add_u32 v8, v7, 4, v8
    v_add_u32 v9, s43, v2
    v_mul_u32_u24 v9, 7168, v9
    s_mul_i32 s46, s28, 448
    s_lshl_b32 s47, s42, 7
    s_add_u32 s46, s46, s47
    v_add_u32 v9, v9, v8
    v_add_u32 v227, s46, v9
    s_add_u32 s41, s40, 4
    s_lshr_b32 s42, s41, 3
    s_and_b32 s43, s41, 7
    s_lshl_b32 s43, s43, 3
    s_and_b32 s45, s41, 1
    s_lshl_b32 s45, s45, 1
    v_xor_b32 v8, s45, v6
    v_lshlrev_b32 v8, 5, v8
    v_lshl_add_u32 v8, v7, 4, v8
    v_add_u32 v9, s43, v2
    v_mul_u32_u24 v9, 7168, v9
    s_mul_i32 s46, s28, 448
    s_lshl_b32 s47, s42, 7
    s_add_u32 s46, s46, s47
    v_add_u32 v9, v9, v8
    v_add_u32 v228, s46, v9
    s_add_u32 s41, s40, 5
    s_lshr_b32 s42, s41, 3
    s_and_b32 s43, s41, 7
    s_lshl_b32 s43, s43, 3
    s_and_b32 s45, s41, 1
    s_lshl_b32 s45, s45, 1
    v_xor_b32 v8, s45, v6
    v_lshlrev_b32 v8, 5, v8
    v_lshl_add_u32 v8, v7, 4, v8
    v_add_u32 v9, s43, v2
    v_mul_u32_u24 v9, 7168, v9
    s_mul_i32 s46, s28, 448
    s_lshl_b32 s47, s42, 7
    s_add_u32 s46, s46, s47
    v_add_u32 v9, v9, v8
    v_add_u32 v229, s46, v9
    s_add_u32 s41, s40, 6
    s_lshr_b32 s42, s41, 3
    s_and_b32 s43, s41, 7
    s_lshl_b32 s43, s43, 3
    s_and_b32 s45, s41, 1
    s_lshl_b32 s45, s45, 1
    v_xor_b32 v8, s45, v6
    v_lshlrev_b32 v8, 5, v8
    v_lshl_add_u32 v8, v7, 4, v8
    v_add_u32 v9, s43, v2
    v_mul_u32_u24 v9, 7168, v9
    s_mul_i32 s46, s28, 448
    s_lshl_b32 s47, s42, 7
    s_add_u32 s46, s46, s47
    v_add_u32 v9, v9, v8
    v_add_u32 v230, s46, v9
    s_add_u32 s41, s40, 7
    s_lshr_b32 s42, s41, 3
    s_and_b32 s43, s41, 7
    s_lshl_b32 s43, s43, 3
    s_and_b32 s45, s41, 1
    s_lshl_b32 s45, s45, 1
    v_xor_b32 v8, s45, v6
    v_lshlrev_b32 v8, 5, v8
    v_lshl_add_u32 v8, v7, 4, v8
    v_add_u32 v9, s43, v2
    v_mul_u32_u24 v9, 7168, v9
    s_mul_i32 s46, s28, 448
    s_lshl_b32 s47, s42, 7
    s_add_u32 s46, s46, s47
    v_add_u32 v9, v9, v8
    v_add_u32 v231, s46, v9
    s_lshl_b32 s30, s24, 12
    s_mul_i32 s31, s24, 8192
    s_add_u32 s31, s31, 16384
    s_mov_b32 s20, 0
    s_mov_b32 s21, 0
    s_mov_b32 s23, 0
    s_add_u32 m0, s23, s30
    s_nop 0
    buffer_load_dwordx4 v220, s[8:11], s20 offen lds
    s_add_u32 m0, m0, 1024
    s_nop 0
    buffer_load_dwordx4 v221, s[8:11], s20 offen lds
    s_add_u32 m0, m0, 1024
    s_nop 0
    buffer_load_dwordx4 v222, s[8:11], s20 offen lds
    s_add_u32 m0, m0, 1024
    s_nop 0
    buffer_load_dwordx4 v223, s[8:11], s20 offen lds
    s_add_u32 m0, s23, s31
    s_nop 0
    buffer_load_dwordx4 v224, s[12:15], s21 offen lds
    s_add_u32 m0, m0, 1024
    s_nop 0
    buffer_load_dwordx4 v225, s[12:15], s21 offen lds
    s_add_u32 m0, m0, 1024
    s_nop 0
    buffer_load_dwordx4 v226, s[12:15], s21 offen lds
    s_add_u32 m0, m0, 1024
    s_nop 0
    buffer_load_dwordx4 v227, s[12:15], s21 offen lds
    s_add_u32 m0, m0, 1024
    s_nop 0
    buffer_load_dwordx4 v228, s[12:15], s21 offen lds
    s_add_u32 m0, m0, 1024
    s_nop 0
    buffer_load_dwordx4 v229, s[12:15], s21 offen lds
    s_add_u32 m0, m0, 1024
    s_nop 0
    buffer_load_dwordx4 v230, s[12:15], s21 offen lds
    s_add_u32 m0, m0, 1024
    s_nop 0
    buffer_load_dwordx4 v231, s[12:15], s21 offen lds
    s_add_u32 s20, s20, 128
    s_add_u32 s21, s21, 458752
    s_add_u32 s23, s23, 49152
    s_cmp_eq_u32 s23, 147456
    s_cselect_b32 s23, 0, s23
    s_add_u32 m0, s23, s30
    s_nop 0
    buffer_load_dwordx4 v220, s[8:11], s20 offen lds
    s_add_u32 m0, m0, 1024
    s_nop 0
    buffer_load_dwordx4 v221, s[8:11], s20 offen lds
    s_add_u32 m0, m0, 1024
    s_nop 0
    buffer_load_dwordx4 v222, s[8:11], s20 offen lds
    s_add_u32 m0, m0, 1024
    s_nop 0
    buffer_load_dwordx4 v223, s[8:11], s20 offen lds
    s_add_u32 m0, s23, s31
    s_nop 0
    buffer_load_dwordx4 v224, s[12:15], s21 offen lds
    s_add_u32 m0, m0, 1024
    s_nop 0
    buffer_load_dwordx4 v225, s[12:15], s21 offen lds
    s_add_u32 m0, m0, 1024
    s_nop 0
    buffer_load_dwordx4 v226, s[12:15], s21 offen lds
    s_add_u32 m0, m0, 1024
    s_nop 0
    buffer_load_dwordx4 v227, s[12:15], s21 offen lds
    s_add_u32 m0, m0, 1024
    s_nop 0
    buffer_load_dwordx4 v228, s[12:15], s21 offen lds
    s_add_u32 m0, m0, 1024
    s_nop 0
    buffer_load_dwordx4 v229, s[12:15], s21 offen lds
    s_add_u32 m0, m0, 1024
    s_nop 0
    buffer_load_dwordx4 v230, s[12:15], s21 offen lds
    s_add_u32 m0, m0, 1024
    s_nop 0
    buffer_load_dwordx4 v231, s[12:15], s21 offen lds
    s_add_u32 s20, s20, 128
    s_add_u32 s21, s21, 458752
    s_add_u32 s23, s23, 49152
    s_cmp_eq_u32 s23, 147456
    s_cselect_b32 s23, 0, s23
    s_add_u32 m0, s23, s30
    s_nop 0
    buffer_load_dwordx4 v220, s[8:11], s20 offen lds
    s_add_u32 m0, m0, 1024
    s_nop 0
    buffer_load_dwordx4 v221, s[8:11], s20 offen lds
    s_add_u32 m0, m0, 1024
    s_nop 0
    buffer_load_dwordx4 v222, s[8:11], s20 offen lds
    s_add_u32 m0, m0, 1024
    s_nop 0
    buffer_load_dwordx4 v223, s[8:11], s20 offen lds
    s_add_u32 m0, s23, s31
    s_nop 0
    buffer_load_dwordx4 v224, s[12:15], s21 offen lds
    s_add_u32 m0, m0, 1024
    s_nop 0
    buffer_load_dwordx4 v225, s[12:15], s21 offen lds
    s_add_u32 m0, m0, 1024
    s_nop 0
    buffer_load_dwordx4 v226, s[12:15], s21 offen lds
    s_add_u32 m0, m0, 1024
    s_nop 0
    buffer_load_dwordx4 v227, s[12:15], s21 offen lds
    s_add_u32 m0, m0, 1024
    s_nop 0
    buffer_load_dwordx4 v228, s[12:15], s21 offen lds
    s_add_u32 m0, m0, 1024
    s_nop 0
    buffer_load_dwordx4 v229, s[12:15], s21 offen lds
    s_add_u32 m0, m0, 1024
    s_nop 0
    buffer_load_dwordx4 v230, s[12:15], s21 offen lds
    s_add_u32 m0, m0, 1024
    s_nop 0
    buffer_load_dwordx4 v231, s[12:15], s21 offen lds
    s_add_u32 s20, s20, 128
    s_add_u32 s21, s21, 458752
    s_add_u32 s23, s23, 49152
    s_cmp_eq_u32 s23, 147456
    s_cselect_b32 s23, 0, s23
    s_waitcnt vmcnt(24)
    s_barrier
    s_mov_b32 s22, 13
L_gemm_w1_kernel_lloop:
    s_waitcnt vmcnt(12)
    s_barrier
    s_add_u32 m0, s23, s30
    s_nop 0
    buffer_load_dwordx4 v220, s[8:11], s20 offen lds
    s_add_u32 m0, m0, 1024
    s_nop 0
    buffer_load_dwordx4 v221, s[8:11], s20 offen lds
    s_add_u32 m0, m0, 1024
    s_nop 0
    buffer_load_dwordx4 v222, s[8:11], s20 offen lds
    s_add_u32 m0, m0, 1024
    s_nop 0
    buffer_load_dwordx4 v223, s[8:11], s20 offen lds
    s_add_u32 m0, s23, s31
    s_nop 0
    buffer_load_dwordx4 v224, s[12:15], s21 offen lds
    s_add_u32 m0, m0, 1024
    s_nop 0
    buffer_load_dwordx4 v225, s[12:15], s21 offen lds
    s_add_u32 m0, m0, 1024
    s_nop 0
    buffer_load_dwordx4 v226, s[12:15], s21 offen lds
    s_add_u32 m0, m0, 1024
    s_nop 0
    buffer_load_dwordx4 v227, s[12:15], s21 offen lds
    s_add_u32 m0, m0, 1024
    s_nop 0
    buffer_load_dwordx4 v228, s[12:15], s21 offen lds
    s_add_u32 m0, m0, 1024
    s_nop 0
    buffer_load_dwordx4 v229, s[12:15], s21 offen lds
    s_add_u32 m0, m0, 1024
    s_nop 0
    buffer_load_dwordx4 v230, s[12:15], s21 offen lds
    s_add_u32 m0, m0, 1024
    s_nop 0
    buffer_load_dwordx4 v231, s[12:15], s21 offen lds
    s_add_u32 s20, s20, 128
    s_add_u32 s21, s21, 458752
    s_add_u32 s23, s23, 49152
    s_cmp_eq_u32 s23, 147456
    s_cselect_b32 s23, 0, s23
    s_sub_u32 s22, s22, 1
    s_cmp_lg_u32 s22, 0
    s_cbranch_scc1 L_gemm_w1_kernel_lloop
    s_waitcnt vmcnt(0)
    s_barrier
    s_waitcnt vmcnt(0)
    s_barrier
    s_endpgm
L_gemm_w1_kernel_compute:
    v_lshrrev_b32 v4, 4, v1
    v_and_b32 v2, 15, v1
    v_lshrrev_b32 v3, 1, v2
    s_lshl_b32 s40, s25, 13
    v_lshl_add_u32 v5, v2, 7, s40
    v_xor_b32 v6, v4, v3
    v_lshl_add_u32 v232, v6, 4, v5
    v_xor_b32 v6, 4, v6
    v_lshl_add_u32 v233, v6, 4, v5
    v_lshrrev_b32 v5, 2, v2
    v_lshl_add_u32 v6, v4, 3, v5
    v_lshlrev_b32 v6, 7, v6
    v_and_b32 v7, 3, v1
    v_lshl_add_u32 v6, v7, 3, v6
    v_add_u32 v6, 16384, v6
    v_lshrrev_b32 v5, 1, v5
    v_and_b32 v7, 1, v4
    v_lshl_add_u32 v5, v7, 1, v5
    s_mul_i32 s40, s26, 7
    s_add_u32 s40, s40, 0
    s_and_b32 s41, s40, 3
    s_lshr_b32 s42, s40, 2
    s_lshl_b32 s42, s42, 13
    v_xor_b32 v7, s41, v5
    v_lshl_add_u32 v7, v7, 5, v6
    v_add_u32 v236, s42, v7
    v_mov_b32 v244, v236
    s_mul_i32 s40, s26, 7
    s_add_u32 s40, s40, 1
    s_and_b32 s41, s40, 3
    s_lshr_b32 s42, s40, 2
    s_lshl_b32 s42, s42, 13
    v_xor_b32 v7, s41, v5
    v_lshl_add_u32 v7, v7, 5, v6
    v_add_u32 v237, s42, v7
    v_mov_b32 v245, v237
    s_mul_i32 s40, s26, 7
    s_add_u32 s40, s40, 2
    s_and_b32 s41, s40, 3
    s_lshr_b32 s42, s40, 2
    s_lshl_b32 s42, s42, 13
    v_xor_b32 v7, s41, v5
    v_lshl_add_u32 v7, v7, 5, v6
    v_add_u32 v238, s42, v7
    v_mov_b32 v246, v238
    s_mul_i32 s40, s26, 7
    s_add_u32 s40, s40, 3
    s_and_b32 s41, s40, 3
    s_lshr_b32 s42, s40, 2
    s_lshl_b32 s42, s42, 13
    v_xor_b32 v7, s41, v5
    v_lshl_add_u32 v7, v7, 5, v6
    v_add_u32 v239, s42, v7
    v_mov_b32 v247, v239
    s_mul_i32 s40, s26, 7
    s_add_u32 s40, s40, 4
    s_and_b32 s41, s40, 3
    s_lshr_b32 s42, s40, 2
    s_lshl_b32 s42, s42, 13
    v_xor_b32 v7, s41, v5
    v_lshl_add_u32 v7, v7, 5, v6
    v_add_u32 v240, s42, v7
    v_mov_b32 v248, v240
    s_mul_i32 s40, s26, 7
    s_add_u32 s40, s40, 5
    s_and_b32 s41, s40, 3
    s_lshr_b32 s42, s40, 2
    s_lshl_b32 s42, s42, 13
    v_xor_b32 v7, s41, v5
    v_lshl_add_u32 v7, v7, 5, v6
    v_add_u32 v241, s42, v7
    v_mov_b32 v249, v241
    s_mul_i32 s40, s26, 7
    s_add_u32 s40, s40, 6
    s_and_b32 s41, s40, 3
    s_lshr_b32 s42, s40, 2
    s_lshl_b32 s42, s42, 13
    v_xor_b32 v7, s41, v5
    v_lshl_add_u32 v7, v7, 5, v6
    v_add_u32 v242, s42, v7
    v_mov_b32 v250, v242
    s_mov_b32 s32, 49152
    s_mov_b32 s33, 49152
    s_mov_b32 s34, 4294868992
    v_mov_b32 v16, 0
    v_mov_b32 v17, 0
    v_mov_b32 v18, 0
    v_mov_b32 v19, 0
    v_mov_b32 v20, 0
    v_mov_b32 v21, 0
    v_mov_b32 v22, 0
    v_mov_b32 v23, 0
    v_mov_b32 v24, 0
    v_mov_b32 v25, 0
    v_mov_b32 v26, 0
    v_mov_b32 v27, 0
    v_mov_b32 v28, 0
    v_mov_b32 v29, 0
    v_mov_b32 v30, 0
    v_mov_b32 v31, 0
    v_mov_b32 v32, 0
    v_mov_b32 v33, 0
    v_mov_b32 v34, 0
    v_mov_b32 v35, 0
    v_mov_b32 v36, 0
    v_mov_b32 v37, 0
    v_mov_b32 v38, 0
    v_mov_b32 v39, 0
    v_mov_b32 v40, 0
    v_mov_b32 v41, 0
    v_mov_b32 v42, 0
    v_mov_b32 v43, 0
    v_mov_b32 v44, 0
    v_mov_b32 v45, 0
    v_mov_b32 v46, 0
    v_mov_b32 v47, 0
    v_mov_b32 v48, 0
    v_mov_b32 v49, 0
    v_mov_b32 v50, 0
    v_mov_b32 v51, 0
    v_mov_b32 v52, 0
    v_mov_b32 v53, 0
    v_mov_b32 v54, 0
    v_mov_b32 v55, 0
    v_mov_b32 v56, 0
    v_mov_b32 v57, 0
    v_mov_b32 v58, 0
    v_mov_b32 v59, 0
    v_mov_b32 v60, 0
    v_mov_b32 v61, 0
    v_mov_b32 v62, 0
    v_mov_b32 v63, 0
    v_mov_b32 v64, 0
    v_mov_b32 v65, 0
    v_mov_b32 v66, 0
    v_mov_b32 v67, 0
    v_mov_b32 v68, 0
    v_mov_b32 v69, 0
    v_mov_b32 v70, 0
    v_mov_b32 v71, 0
    v_mov_b32 v72, 0
    v_mov_b32 v73, 0
    v_mov_b32 v74, 0
    v_mov_b32 v75, 0
    v_mov_b32 v76, 0
    v_mov_b32 v77, 0
    v_mov_b32 v78, 0
    v_mov_b32 v79, 0
    v_mov_b32 v80, 0
    v_mov_b32 v81, 0
    v_mov_b32 v82, 0
    v_mov_b32 v83, 0
    v_mov_b32 v84, 0
    v_mov_b32 v85, 0
    v_mov_b32 v86, 0
    v_mov_b32 v87, 0
    v_mov_b32 v88, 0
    v_mov_b32 v89, 0
    v_mov_b32 v90, 0
    v_mov_b32 v91, 0
    v_mov_b32 v92, 0
    v_mov_b32 v93, 0
    v_mov_b32 v94, 0
    v_mov_b32 v95, 0
    v_mov_b32 v96, 0
    v_mov_b32 v97, 0
    v_mov_b32 v98, 0
    v_mov_b32 v99, 0
    v_mov_b32 v100, 0
    v_mov_b32 v101, 0
    v_mov_b32 v102, 0
    v_mov_b32 v103, 0
    v_mov_b32 v104, 0
    v_mov_b32 v105, 0
    v_mov_b32 v106, 0
    v_mov_b32 v107, 0
    v_mov_b32 v108, 0
    v_mov_b32 v109, 0
    v_mov_b32 v110, 0
    v_mov_b32 v111, 0
    v_mov_b32 v112, 0
    v_mov_b32 v113, 0
    v_mov_b32 v114, 0
    v_mov_b32 v115, 0
    v_mov_b32 v116, 0
    v_mov_b32 v117, 0
    v_mov_b32 v118, 0
    v_mov_b32 v119, 0
    v_mov_b32 v120, 0
    v_mov_b32 v121, 0
    v_mov_b32 v122, 0
    v_mov_b32 v123, 0
    v_mov_b32 v124, 0
    v_mov_b32 v125, 0
    v_mov_b32 v126, 0
    v_mov_b32 v127, 0
    s_barrier
    ds_read_b128 v[128:131], v232 offset:0
    ds_read_b128 v[132:135], v232 offset:2048
    ds_read_b128 v[136:139], v232 offset:4096
    ds_read_b128 v[140:143], v232 offset:6144
    ds_read_b64_tr_b16 v[144:145], v236 offset:0
    ds_read_b64_tr_b16 v[146:147], v236 offset:512
    ds_read_b64_tr_b16 v[148:149], v237 offset:0
    ds_read_b64_tr_b16 v[150:151], v237 offset:512
    ds_read_b64_tr_b16 v[152:153], v238 offset:0
    ds_read_b64_tr_b16 v[154:155], v238 offset:512
    ds_read_b64_tr_b16 v[156:157], v239 offset:0
    ds_read_b64_tr_b16 v[158:159], v239 offset:512
    ds_read_b64_tr_b16 v[160:161], v240 offset:0
    ds_read_b64_tr_b16 v[162:163], v240 offset:512
    ds_read_b64_tr_b16 v[164:165], v241 offset:0
    ds_read_b64_tr_b16 v[166:167], v241 offset:512
    ds_read_b64_tr_b16 v[168:169], v242 offset:0
    ds_read_b64_tr_b16 v[170:171], v242 offset:512
    v_add_u32 v232, s32, v232
    v_add_u32 v236, s32, v236
    v_add_u32 v237, s32, v237
    v_add_u32 v238, s32, v238
    v_add_u32 v239, s32, v239
    v_add_u32 v240, s32, v240
    v_add_u32 v241, s32, v241
    v_add_u32 v242, s32, v242
    s_mov_b32 s22, 15
L_gemm_w1_kernel_loop:
    s_waitcnt lgkmcnt(0)
    v_mfma_f32_16x16x32_bf16 v[16:19], v[144:147], v[128:131], v[16:19]
    ds_read_b128 v[176:179], v233 offset:0
    v_mfma_f32_16x16x32_bf16 v[44:47], v[144:147], v[132:135], v[44:47]
    ds_read_b128 v[180:183], v233 offset:2048
    v_mfma_f32_16x16x32_bf16 v[72:75], v[144:147], v[136:139], v[72:75]
    ds_read_b128 v[184:187], v233 offset:4096
    v_mfma_f32_16x16x32_bf16 v[100:103], v[144:147], v[140:143], v[100:103]
    ds_read_b128 v[188:191], v233 offset:6144
    v_mfma_f32_16x16x32_bf16 v[20:23], v[148:151], v[128:131], v[20:23]
    ds_read_b64_tr_b16 v[192:193], v244 offset:4096
    v_mfma_f32_16x16x32_bf16 v[48:51], v[148:151], v[132:135], v[48:51]
    ds_read_b64_tr_b16 v[194:195], v244 offset:4608
    v_mfma_f32_16x16x32_bf16 v[76:79], v[148:151], v[136:139], v[76:79]
    ds_read_b64_tr_b16 v[196:197], v245 offset:4096
    v_mfma_f32_16x16x32_bf16 v[104:107], v[148:151], v[140:143], v[104:107]
    ds_read_b64_tr_b16 v[198:199], v245 offset:4608
    v_mfma_f32_16x16x32_bf16 v[24:27], v[152:155], v[128:131], v[24:27]
    ds_read_b64_tr_b16 v[200:201], v246 offset:4096
    v_mfma_f32_16x16x32_bf16 v[52:55], v[152:155], v[132:135], v[52:55]
    ds_read_b64_tr_b16 v[202:203], v246 offset:4608
    v_mfma_f32_16x16x32_bf16 v[80:83], v[152:155], v[136:139], v[80:83]
    ds_read_b64_tr_b16 v[204:205], v247 offset:4096
    v_mfma_f32_16x16x32_bf16 v[108:111], v[152:155], v[140:143], v[108:111]
    ds_read_b64_tr_b16 v[206:207], v247 offset:4608
    v_mfma_f32_16x16x32_bf16 v[28:31], v[156:159], v[128:131], v[28:31]
    ds_read_b64_tr_b16 v[208:209], v248 offset:4096
    v_mfma_f32_16x16x32_bf16 v[56:59], v[156:159], v[132:135], v[56:59]
    ds_read_b64_tr_b16 v[210:211], v248 offset:4608
    v_mfma_f32_16x16x32_bf16 v[84:87], v[156:159], v[136:139], v[84:87]
    ds_read_b64_tr_b16 v[212:213], v249 offset:4096
    v_mfma_f32_16x16x32_bf16 v[112:115], v[156:159], v[140:143], v[112:115]
    ds_read_b64_tr_b16 v[214:215], v249 offset:4608
    v_mfma_f32_16x16x32_bf16 v[32:35], v[160:163], v[128:131], v[32:35]
    ds_read_b64_tr_b16 v[216:217], v250 offset:4096
    v_mfma_f32_16x16x32_bf16 v[60:63], v[160:163], v[132:135], v[60:63]
    ds_read_b64_tr_b16 v[218:219], v250 offset:4608
    v_mfma_f32_16x16x32_bf16 v[88:91], v[160:163], v[136:139], v[88:91]
    v_add_u32 v233, s32, v233
    v_mfma_f32_16x16x32_bf16 v[116:119], v[160:163], v[140:143], v[116:119]
    v_add_u32 v244, s32, v244
    v_mfma_f32_16x16x32_bf16 v[36:39], v[164:167], v[128:131], v[36:39]
    v_add_u32 v245, s32, v245
    v_mfma_f32_16x16x32_bf16 v[64:67], v[164:167], v[132:135], v[64:67]
    v_add_u32 v246, s32, v246
    v_mfma_f32_16x16x32_bf16 v[92:95], v[164:167], v[136:139], v[92:95]
    v_add_u32 v247, s32, v247
    v_mfma_f32_16x16x32_bf16 v[120:123], v[164:167], v[140:143], v[120:123]
    v_add_u32 v248, s32, v248
    v_mfma_f32_16x16x32_bf16 v[40:43], v[168:171], v[128:131], v[40:43]
    v_add_u32 v249, s32, v249
    v_mfma_f32_16x16x32_bf16 v[68:71], v[168:171], v[132:135], v[68:71]
    v_add_u32 v250, s32, v250
    v_mfma_f32_16x16x32_bf16 v[96:99], v[168:171], v[136:139], v[96:99]
    v_mfma_f32_16x16x32_bf16 v[124:127], v[168:171], v[140:143], v[124:127]
    s_waitcnt lgkmcnt(0)
    s_barrier
    v_mfma_f32_16x16x32_bf16 v[16:19], v[192:195], v[176:179], v[16:19]
    ds_read_b128 v[128:131], v232 offset:0
    ds_read_b128 v[132:135], v232 offset:2048
    v_mfma_f32_16x16x32_bf16 v[44:47], v[192:195], v[180:183], v[44:47]
    ds_read_b128 v[136:139], v232 offset:4096
    ds_read_b128 v[140:143], v232 offset:6144
    v_mfma_f32_16x16x32_bf16 v[72:75], v[192:195], v[184:187], v[72:75]
    ds_read_b64_tr_b16 v[144:145], v236 offset:0
    v_mfma_f32_16x16x32_bf16 v[100:103], v[192:195], v[188:191], v[100:103]
    ds_read_b64_tr_b16 v[146:147], v236 offset:512
    v_mfma_f32_16x16x32_bf16 v[20:23], v[196:199], v[176:179], v[20:23]
    ds_read_b64_tr_b16 v[148:149], v237 offset:0
    v_mfma_f32_16x16x32_bf16 v[48:51], v[196:199], v[180:183], v[48:51]
    ds_read_b64_tr_b16 v[150:151], v237 offset:512
    v_mfma_f32_16x16x32_bf16 v[76:79], v[196:199], v[184:187], v[76:79]
    ds_read_b64_tr_b16 v[152:153], v238 offset:0
    v_mfma_f32_16x16x32_bf16 v[104:107], v[196:199], v[188:191], v[104:107]
    ds_read_b64_tr_b16 v[154:155], v238 offset:512
    v_mfma_f32_16x16x32_bf16 v[24:27], v[200:203], v[176:179], v[24:27]
    ds_read_b64_tr_b16 v[156:157], v239 offset:0
    v_mfma_f32_16x16x32_bf16 v[52:55], v[200:203], v[180:183], v[52:55]
    ds_read_b64_tr_b16 v[158:159], v239 offset:512
    v_mfma_f32_16x16x32_bf16 v[80:83], v[200:203], v[184:187], v[80:83]
    ds_read_b64_tr_b16 v[160:161], v240 offset:0
    v_mfma_f32_16x16x32_bf16 v[108:111], v[200:203], v[188:191], v[108:111]
    ds_read_b64_tr_b16 v[162:163], v240 offset:512
    v_mfma_f32_16x16x32_bf16 v[28:31], v[204:207], v[176:179], v[28:31]
    ds_read_b64_tr_b16 v[164:165], v241 offset:0
    v_mfma_f32_16x16x32_bf16 v[56:59], v[204:207], v[180:183], v[56:59]
    ds_read_b64_tr_b16 v[166:167], v241 offset:512
    v_mfma_f32_16x16x32_bf16 v[84:87], v[204:207], v[184:187], v[84:87]
    ds_read_b64_tr_b16 v[168:169], v242 offset:0
    v_mfma_f32_16x16x32_bf16 v[112:115], v[204:207], v[188:191], v[112:115]
    ds_read_b64_tr_b16 v[170:171], v242 offset:512
    v_mfma_f32_16x16x32_bf16 v[32:35], v[208:211], v[176:179], v[32:35]
    v_add_u32 v232, s33, v232
    v_mfma_f32_16x16x32_bf16 v[60:63], v[208:211], v[180:183], v[60:63]
    v_add_u32 v236, s33, v236
    v_mfma_f32_16x16x32_bf16 v[88:91], v[208:211], v[184:187], v[88:91]
    v_add_u32 v237, s33, v237
    v_mfma_f32_16x16x32_bf16 v[116:119], v[208:211], v[188:191], v[116:119]
    v_add_u32 v238, s33, v238
    v_mfma_f32_16x16x32_bf16 v[36:39], v[212:215], v[176:179], v[36:39]
    v_add_u32 v239, s33, v239
    v_mfma_f32_16x16x32_bf16 v[64:67], v[212:215], v[180:183], v[64:67]
    v_add_u32 v240, s33, v240
    v_mfma_f32_16x16x32_bf16 v[92:95], v[212:215], v[184:187], v[92:95]
    v_add_u32 v241, s33, v241
    v_mfma_f32_16x16x32_bf16 v[120:123], v[212:215], v[188:191], v[120:123]
    v_add_u32 v242, s33, v242
    v_mfma_f32_16x16x32_bf16 v[40:43], v[216:219], v[176:179], v[40:43]
    s_mov_b32 s35, s32
    v_mfma_f32_16x16x32_bf16 v[68:71], v[216:219], v[180:183], v[68:71]
    s_mov_b32 s32, s33
    v_mfma_f32_16x16x32_bf16 v[96:99], v[216:219], v[184:187], v[96:99]
    s_mov_b32 s33, s34
    v_mfma_f32_16x16x32_bf16 v[124:127], v[216:219], v[188:191], v[124:127]
    s_mov_b32 s34, s35
    s_sub_u32 s22, s22, 1
    s_cmp_lg_u32 s22, 0
    s_cbranch_scc1 L_gemm_w1_kernel_loop
    s_waitcnt lgkmcnt(0)
    v_mfma_f32_16x16x32_bf16 v[16:19], v[144:147], v[128:131], v[16:19]
    ds_read_b128 v[176:179], v233 offset:0
    v_mfma_f32_16x16x32_bf16 v[44:47], v[144:147], v[132:135], v[44:47]
    ds_read_b128 v[180:183], v233 offset:2048
    v_mfma_f32_16x16x32_bf16 v[72:75], v[144:147], v[136:139], v[72:75]
    ds_read_b128 v[184:187], v233 offset:4096
    v_mfma_f32_16x16x32_bf16 v[100:103], v[144:147], v[140:143], v[100:103]
    ds_read_b128 v[188:191], v233 offset:6144
    v_mfma_f32_16x16x32_bf16 v[20:23], v[148:151], v[128:131], v[20:23]
    ds_read_b64_tr_b16 v[192:193], v244 offset:4096
    v_mfma_f32_16x16x32_bf16 v[48:51], v[148:151], v[132:135], v[48:51]
    ds_read_b64_tr_b16 v[194:195], v244 offset:4608
    v_mfma_f32_16x16x32_bf16 v[76:79], v[148:151], v[136:139], v[76:79]
    ds_read_b64_tr_b16 v[196:197], v245 offset:4096
    v_mfma_f32_16x16x32_bf16 v[104:107], v[148:151], v[140:143], v[104:107]
    ds_read_b64_tr_b16 v[198:199], v245 offset:4608
    v_mfma_f32_16x16x32_bf16 v[24:27], v[152:155], v[128:131], v[24:27]
    ds_read_b64_tr_b16 v[200:201], v246 offset:4096
    v_mfma_f32_16x16x32_bf16 v[52:55], v[152:155], v[132:135], v[52:55]
    ds_read_b64_tr_b16 v[202:203], v246 offset:4608
    v_mfma_f32_16x16x32_bf16 v[80:83], v[152:155], v[136:139], v[80:83]
    ds_read_b64_tr_b16 v[204:205], v247 offset:4096
    v_mfma_f32_16x16x32_bf16 v[108:111], v[152:155], v[140:143], v[108:111]
    ds_read_b64_tr_b16 v[206:207], v247 offset:4608
    v_mfma_f32_16x16x32_bf16 v[28:31], v[156:159], v[128:131], v[28:31]
    ds_read_b64_tr_b16 v[208:209], v248 offset:4096
    v_mfma_f32_16x16x32_bf16 v[56:59], v[156:159], v[132:135], v[56:59]
    ds_read_b64_tr_b16 v[210:211], v248 offset:4608
    v_mfma_f32_16x16x32_bf16 v[84:87], v[156:159], v[136:139], v[84:87]
    ds_read_b64_tr_b16 v[212:213], v249 offset:4096
    v_mfma_f32_16x16x32_bf16 v[112:115], v[156:159], v[140:143], v[112:115]
    ds_read_b64_tr_b16 v[214:215], v249 offset:4608
    v_mfma_f32_16x16x32_bf16 v[32:35], v[160:163], v[128:131], v[32:35]
    ds_read_b64_tr_b16 v[216:217], v250 offset:4096
    v_mfma_f32_16x16x32_bf16 v[60:63], v[160:163], v[132:135], v[60:63]
    ds_read_b64_tr_b16 v[218:219], v250 offset:4608
    v_mfma_f32_16x16x32_bf16 v[88:91], v[160:163], v[136:139], v[88:91]
    v_add_u32 v233, s32, v233
    v_mfma_f32_16x16x32_bf16 v[116:119], v[160:163], v[140:143], v[116:119]
    v_add_u32 v244, s32, v244
    v_mfma_f32_16x16x32_bf16 v[36:39], v[164:167], v[128:131], v[36:39]
    v_add_u32 v245, s32, v245
    v_mfma_f32_16x16x32_bf16 v[64:67], v[164:167], v[132:135], v[64:67]
    v_add_u32 v246, s32, v246
    v_mfma_f32_16x16x32_bf16 v[92:95], v[164:167], v[136:139], v[92:95]
    v_add_u32 v247, s32, v247
    v_mfma_f32_16x16x32_bf16 v[120:123], v[164:167], v[140:143], v[120:123]
    v_add_u32 v248, s32, v248
    v_mfma_f32_16x16x32_bf16 v[40:43], v[168:171], v[128:131], v[40:43]
    v_add_u32 v249, s32, v249
    v_mfma_f32_16x16x32_bf16 v[68:71], v[168:171], v[132:135], v[68:71]
    v_add_u32 v250, s32, v250
    v_mfma_f32_16x16x32_bf16 v[96:99], v[168:171], v[136:139], v[96:99]
    v_mfma_f32_16x16x32_bf16 v[124:127], v[168:171], v[140:143], v[124:127]
    s_waitcnt lgkmcnt(0)
    v_mfma_f32_16x16x32_bf16 v[16:19], v[192:195], v[176:179], v[16:19]
    s_mov_b32 s35, s32
    v_mfma_f32_16x16x32_bf16 v[44:47], v[192:195], v[180:183], v[44:47]
    s_mov_b32 s32, s33
    v_mfma_f32_16x16x32_bf16 v[72:75], v[192:195], v[184:187], v[72:75]
    s_mov_b32 s33, s34
    v_mfma_f32_16x16x32_bf16 v[100:103], v[192:195], v[188:191], v[100:103]
    s_mov_b32 s34, s35
    v_mfma_f32_16x16x32_bf16 v[20:23], v[196:199], v[176:179], v[20:23]
    v_mfma_f32_16x16x32_bf16 v[48:51], v[196:199], v[180:183], v[48:51]
    v_mfma_f32_16x16x32_bf16 v[76:79], v[196:199], v[184:187], v[76:79]
    v_mfma_f32_16x16x32_bf16 v[104:107], v[196:199], v[188:191], v[104:107]
    v_mfma_f32_16x16x32_bf16 v[24:27], v[200:203], v[176:179], v[24:27]
    v_mfma_f32_16x16x32_bf16 v[52:55], v[200:203], v[180:183], v[52:55]
    v_mfma_f32_16x16x32_bf16 v[80:83], v[200:203], v[184:187], v[80:83]
    v_mfma_f32_16x16x32_bf16 v[108:111], v[200:203], v[188:191], v[108:111]
    v_mfma_f32_16x16x32_bf16 v[28:31], v[204:207], v[176:179], v[28:31]
    v_mfma_f32_16x16x32_bf16 v[56:59], v[204:207], v[180:183], v[56:59]
    v_mfma_f32_16x16x32_bf16 v[84:87], v[204:207], v[184:187], v[84:87]
    v_mfma_f32_16x16x32_bf16 v[112:115], v[204:207], v[188:191], v[112:115]
    v_mfma_f32_16x16x32_bf16 v[32:35], v[208:211], v[176:179], v[32:35]
    v_mfma_f32_16x16x32_bf16 v[60:63], v[208:211], v[180:183], v[60:63]
    v_mfma_f32_16x16x32_bf16 v[88:91], v[208:211], v[184:187], v[88:91]
    v_mfma_f32_16x16x32_bf16 v[116:119], v[208:211], v[188:191], v[116:119]
    v_mfma_f32_16x16x32_bf16 v[36:39], v[212:215], v[176:179], v[36:39]
    v_mfma_f32_16x16x32_bf16 v[64:67], v[212:215], v[180:183], v[64:67]
    v_mfma_f32_16x16x32_bf16 v[92:95], v[212:215], v[184:187], v[92:95]
    v_mfma_f32_16x16x32_bf16 v[120:123], v[212:215], v[188:191], v[120:123]
    v_mfma_f32_16x16x32_bf16 v[40:43], v[216:219], v[176:179], v[40:43]
    v_mfma_f32_16x16x32_bf16 v[68:71], v[216:219], v[180:183], v[68:71]
    v_mfma_f32_16x16x32_bf16 v[96:99], v[216:219], v[184:187], v[96:99]
    v_mfma_f32_16x16x32_bf16 v[124:127], v[216:219], v[188:191], v[124:127]
    s_nop 7
    s_nop 7
    v_and_b32 v1, 63, v0
    v_and_b32 v2, 15, v1
    v_lshrrev_b32 v4, 4, v1
    s_lshl_b32 s40, s27, 7
    s_lshl_b32 s41, s25, 6
    s_add_u32 s40, s40, s41
    v_add_u32 v3, s40, v2
    s_add_u32 s16, s50, 0
    s_addc_u32 s17, s51, 0
    s_mov_b32 s18, 7168
    s_mov_b32 s19, 0x00020000
    s_add_u32 s52, s4, 16777216
    s_addc_u32 s53, s5, 0
    s_mov_b32 s54, 14680064
    s_mov_b32 s55, 0x00020000
    s_mul_i32 s40, s28, 448
    s_mul_i32 s41, s26, 224
    s_add_u32 s40, s40, s41
    v_lshl_add_u32 v5, v4, 3, s40
    buffer_load_dwordx2 v[128:129], v5, s[16:19], 0 offen offset:0
    buffer_load_dwordx2 v[130:131], v5, s[16:19], 0 offen offset:32
    buffer_load_dwordx2 v[132:133], v5, s[16:19], 0 offen offset:64
    buffer_load_dwordx2 v[134:135], v5, s[16:19], 0 offen offset:96
    buffer_load_dwordx2 v[136:137], v5, s[16:19], 0 offen offset:128
    buffer_load_dwordx2 v[138:139], v5, s[16:19], 0 offen offset:160
    buffer_load_dwordx2 v[140:141], v5, s[16:19], 0 offen offset:192
    v_mul_u32_u24 v6, 7168, v3
    v_add_u32 v6, v6, v5
    s_mov_b32 s44, 114688
    s_mov_b32 s45, 229376
    s_mov_b32 s46, 344064
    s_mov_b32 s56, 0x40135761
    s_mov_b32 s57, 0x3dd2d3e8
    s_barrier
    s_lshl_b32 s58, s24, 14
    v_mul_u32_u24 v7, 240, v2
    v_lshl_add_u32 v7, v4, 3, v7
    v_add_u32 v7, s58, v7
    s_waitcnt vmcnt(0)
    v_lshlrev_b32 v176, 16, v128
    v_and_b32 v177, 0xffff0000, v128
    v_lshlrev_b32 v178, 16, v129
    v_and_b32 v179, 0xffff0000, v129
    v_lshlrev_b32 v180, 16, v130
    v_and_b32 v181, 0xffff0000, v130
    v_lshlrev_b32 v182, 16, v131
    v_and_b32 v183, 0xffff0000, v131
    v_lshlrev_b32 v184, 16, v132
    v_and_b32 v185, 0xffff0000, v132
    v_lshlrev_b32 v186, 16, v133
    v_and_b32 v187, 0xffff0000, v133
    v_lshlrev_b32 v188, 16, v134
    v_and_b32 v189, 0xffff0000, v134
    v_lshlrev_b32 v190, 16, v135
    v_and_b32 v191, 0xffff0000, v135
    v_lshlrev_b32 v192, 16, v136
    v_and_b32 v193, 0xffff0000, v136
    v_lshlrev_b32 v194, 16, v137
    v_and_b32 v195, 0xffff0000, v137
    v_lshlrev_b32 v196, 16, v138
    v_and_b32 v197, 0xffff0000, v138
    v_lshlrev_b32 v198, 16, v139
    v_and_b32 v199, 0xffff0000, v139
    v_lshlrev_b32 v200, 16, v140
    v_and_b32 v201, 0xffff0000, v140
    v_lshlrev_b32 v202, 16, v141
    v_and_b32 v203, 0xffff0000, v141
    v_add_f32 v16, v16, v176
    v_add_f32 v17, v17, v177
    v_add_f32 v18, v18, v178
    v_add_f32 v19, v19, v179
    v_mul_f32 v8, v16, v16
    v_mul_f32 v9, v17, v17
    v_mul_f32 v10, v18, v18
    v_mul_f32 v11, v19, v19
    v_mov_b32 v12, s56
    v_fmac_f32 v12, s57, v8
    v_mov_b32 v13, s56
    v_fmac_f32 v13, s57, v9
    v_mov_b32 v14, s56
    v_fmac_f32 v14, s57, v10
    v_mov_b32 v15, s56
    v_fmac_f32 v15, s57, v11
    v_mul_f32 v8, v12, v16
    v_mul_f32 v9, v13, v17
    v_mul_f32 v10, v14, v18
    v_mul_f32 v11, v15, v19
    v_exp_f32 v8, -v8
    v_exp_f32 v9, -v9
    v_exp_f32 v10, -v10
    v_exp_f32 v11, -v11
    v_add_f32 v8, 1.0, v8
    v_add_f32 v9, 1.0, v9
    v_add_f32 v10, 1.0, v10
    v_add_f32 v11, 1.0, v11
    v_rcp_f32 v8, v8
    v_rcp_f32 v9, v9
    v_rcp_f32 v10, v10
    v_rcp_f32 v11, v11
    v_mul_f32 v16, v16, v8
    v_mul_f32 v17, v17, v9
    v_mul_f32 v18, v18, v10
    v_mul_f32 v19, v19, v11
    v_cvt_pk_bf16_f32 v16, v16, v17
    v_cvt_pk_bf16_f32 v17, v18, v19
    ds_write_b64 v7, v[16:17] offset:0
    v_add_f32 v20, v20, v180
    v_add_f32 v21, v21, v181
    v_add_f32 v22, v22, v182
    v_add_f32 v23, v23, v183
    v_mul_f32 v8, v20, v20
    v_mul_f32 v9, v21, v21
    v_mul_f32 v10, v22, v22
    v_mul_f32 v11, v23, v23
    v_mov_b32 v12, s56
    v_fmac_f32 v12, s57, v8
    v_mov_b32 v13, s56
    v_fmac_f32 v13, s57, v9
    v_mov_b32 v14, s56
    v_fmac_f32 v14, s57, v10
    v_mov_b32 v15, s56
    v_fmac_f32 v15, s57, v11
    v_mul_f32 v8, v12, v20
    v_mul_f32 v9, v13, v21
    v_mul_f32 v10, v14, v22
    v_mul_f32 v11, v15, v23
    v_exp_f32 v8, -v8
    v_exp_f32 v9, -v9
    v_exp_f32 v10, -v10
    v_exp_f32 v11, -v11
    v_add_f32 v8, 1.0, v8
    v_add_f32 v9, 1.0, v9
    v_add_f32 v10, 1.0, v10
    v_add_f32 v11, 1.0, v11
    v_rcp_f32 v8, v8
    v_rcp_f32 v9, v9
    v_rcp_f32 v10, v10
    v_rcp_f32 v11, v11
    v_mul_f32 v20, v20, v8
    v_mul_f32 v21, v21, v9
    v_mul_f32 v22, v22, v10
    v_mul_f32 v23, v23, v11
    v_cvt_pk_bf16_f32 v20, v20, v21
    v_cvt_pk_bf16_f32 v21, v22, v23
    ds_write_b64 v7, v[20:21] offset:32
    v_add_f32 v24, v24, v184
    v_add_f32 v25, v25, v185
    v_add_f32 v26, v26, v186
    v_add_f32 v27, v27, v187
    v_mul_f32 v8, v24, v24
    v_mul_f32 v9, v25, v25
    v_mul_f32 v10, v26, v26
    v_mul_f32 v11, v27, v27
    v_mov_b32 v12, s56
    v_fmac_f32 v12, s57, v8
    v_mov_b32 v13, s56
    v_fmac_f32 v13, s57, v9
    v_mov_b32 v14, s56
    v_fmac_f32 v14, s57, v10
    v_mov_b32 v15, s56
    v_fmac_f32 v15, s57, v11
    v_mul_f32 v8, v12, v24
    v_mul_f32 v9, v13, v25
    v_mul_f32 v10, v14, v26
    v_mul_f32 v11, v15, v27
    v_exp_f32 v8, -v8
    v_exp_f32 v9, -v9
    v_exp_f32 v10, -v10
    v_exp_f32 v11, -v11
    v_add_f32 v8, 1.0, v8
    v_add_f32 v9, 1.0, v9
    v_add_f32 v10, 1.0, v10
    v_add_f32 v11, 1.0, v11
    v_rcp_f32 v8, v8
    v_rcp_f32 v9, v9
    v_rcp_f32 v10, v10
    v_rcp_f32 v11, v11
    v_mul_f32 v24, v24, v8
    v_mul_f32 v25, v25, v9
    v_mul_f32 v26, v26, v10
    v_mul_f32 v27, v27, v11
    v_cvt_pk_bf16_f32 v24, v24, v25
    v_cvt_pk_bf16_f32 v25, v26, v27
    ds_write_b64 v7, v[24:25] offset:64
    v_add_f32 v28, v28, v188
    v_add_f32 v29, v29, v189
    v_add_f32 v30, v30, v190
    v_add_f32 v31, v31, v191
    v_mul_f32 v8, v28, v28
    v_mul_f32 v9, v29, v29
    v_mul_f32 v10, v30, v30
    v_mul_f32 v11, v31, v31
    v_mov_b32 v12, s56
    v_fmac_f32 v12, s57, v8
    v_mov_b32 v13, s56
    v_fmac_f32 v13, s57, v9
    v_mov_b32 v14, s56
    v_fmac_f32 v14, s57, v10
    v_mov_b32 v15, s56
    v_fmac_f32 v15, s57, v11
    v_mul_f32 v8, v12, v28
    v_mul_f32 v9, v13, v29
    v_mul_f32 v10, v14, v30
    v_mul_f32 v11, v15, v31
    v_exp_f32 v8, -v8
    v_exp_f32 v9, -v9
    v_exp_f32 v10, -v10
    v_exp_f32 v11, -v11
    v_add_f32 v8, 1.0, v8
    v_add_f32 v9, 1.0, v9
    v_add_f32 v10, 1.0, v10
    v_add_f32 v11, 1.0, v11
    v_rcp_f32 v8, v8
    v_rcp_f32 v9, v9
    v_rcp_f32 v10, v10
    v_rcp_f32 v11, v11
    v_mul_f32 v28, v28, v8
    v_mul_f32 v29, v29, v9
    v_mul_f32 v30, v30, v10
    v_mul_f32 v31, v31, v11
    v_cvt_pk_bf16_f32 v28, v28, v29
    v_cvt_pk_bf16_f32 v29, v30, v31
    ds_write_b64 v7, v[28:29] offset:96
    v_add_f32 v32, v32, v192
    v_add_f32 v33, v33, v193
    v_add_f32 v34, v34, v194
    v_add_f32 v35, v35, v195
    v_mul_f32 v8, v32, v32
    v_mul_f32 v9, v33, v33
    v_mul_f32 v10, v34, v34
    v_mul_f32 v11, v35, v35
    v_mov_b32 v12, s56
    v_fmac_f32 v12, s57, v8
    v_mov_b32 v13, s56
    v_fmac_f32 v13, s57, v9
    v_mov_b32 v14, s56
    v_fmac_f32 v14, s57, v10
    v_mov_b32 v15, s56
    v_fmac_f32 v15, s57, v11
    v_mul_f32 v8, v12, v32
    v_mul_f32 v9, v13, v33
    v_mul_f32 v10, v14, v34
    v_mul_f32 v11, v15, v35
    v_exp_f32 v8, -v8
    v_exp_f32 v9, -v9
    v_exp_f32 v10, -v10
    v_exp_f32 v11, -v11
    v_add_f32 v8, 1.0, v8
    v_add_f32 v9, 1.0, v9
    v_add_f32 v10, 1.0, v10
    v_add_f32 v11, 1.0, v11
    v_rcp_f32 v8, v8
    v_rcp_f32 v9, v9
    v_rcp_f32 v10, v10
    v_rcp_f32 v11, v11
    v_mul_f32 v32, v32, v8
    v_mul_f32 v33, v33, v9
    v_mul_f32 v34, v34, v10
    v_mul_f32 v35, v35, v11
    v_cvt_pk_bf16_f32 v32, v32, v33
    v_cvt_pk_bf16_f32 v33, v34, v35
    ds_write_b64 v7, v[32:33] offset:128
    v_add_f32 v36, v36, v196
    v_add_f32 v37, v37, v197
    v_add_f32 v38, v38, v198
    v_add_f32 v39, v39, v199
    v_mul_f32 v8, v36, v36
    v_mul_f32 v9, v37, v37
    v_mul_f32 v10, v38, v38
    v_mul_f32 v11, v39, v39
    v_mov_b32 v12, s56
    v_fmac_f32 v12, s57, v8
    v_mov_b32 v13, s56
    v_fmac_f32 v13, s57, v9
    v_mov_b32 v14, s56
    v_fmac_f32 v14, s57, v10
    v_mov_b32 v15, s56
    v_fmac_f32 v15, s57, v11
    v_mul_f32 v8, v12, v36
    v_mul_f32 v9, v13, v37
    v_mul_f32 v10, v14, v38
    v_mul_f32 v11, v15, v39
    v_exp_f32 v8, -v8
    v_exp_f32 v9, -v9
    v_exp_f32 v10, -v10
    v_exp_f32 v11, -v11
    v_add_f32 v8, 1.0, v8
    v_add_f32 v9, 1.0, v9
    v_add_f32 v10, 1.0, v10
    v_add_f32 v11, 1.0, v11
    v_rcp_f32 v8, v8
    v_rcp_f32 v9, v9
    v_rcp_f32 v10, v10
    v_rcp_f32 v11, v11
    v_mul_f32 v36, v36, v8
    v_mul_f32 v37, v37, v9
    v_mul_f32 v38, v38, v10
    v_mul_f32 v39, v39, v11
    v_cvt_pk_bf16_f32 v36, v36, v37
    v_cvt_pk_bf16_f32 v37, v38, v39
    ds_write_b64 v7, v[36:37] offset:160
    v_add_f32 v40, v40, v200
    v_add_f32 v41, v41, v201
    v_add_f32 v42, v42, v202
    v_add_f32 v43, v43, v203
    v_mul_f32 v8, v40, v40
    v_mul_f32 v9, v41, v41
    v_mul_f32 v10, v42, v42
    v_mul_f32 v11, v43, v43
    v_mov_b32 v12, s56
    v_fmac_f32 v12, s57, v8
    v_mov_b32 v13, s56
    v_fmac_f32 v13, s57, v9
    v_mov_b32 v14, s56
    v_fmac_f32 v14, s57, v10
    v_mov_b32 v15, s56
    v_fmac_f32 v15, s57, v11
    v_mul_f32 v8, v12, v40
    v_mul_f32 v9, v13, v41
    v_mul_f32 v10, v14, v42
    v_mul_f32 v11, v15, v43
    v_exp_f32 v8, -v8
    v_exp_f32 v9, -v9
    v_exp_f32 v10, -v10
    v_exp_f32 v11, -v11
    v_add_f32 v8, 1.0, v8
    v_add_f32 v9, 1.0, v9
    v_add_f32 v10, 1.0, v10
    v_add_f32 v11, 1.0, v11
    v_rcp_f32 v8, v8
    v_rcp_f32 v9, v9
    v_rcp_f32 v10, v10
    v_rcp_f32 v11, v11
    v_mul_f32 v40, v40, v8
    v_mul_f32 v41, v41, v9
    v_mul_f32 v42, v42, v10
    v_mul_f32 v43, v43, v11
    v_cvt_pk_bf16_f32 v40, v40, v41
    v_cvt_pk_bf16_f32 v41, v42, v43
    ds_write_b64 v7, v[40:41] offset:192
    v_add_f32 v44, v44, v176
    v_add_f32 v45, v45, v177
    v_add_f32 v46, v46, v178
    v_add_f32 v47, v47, v179
    v_mul_f32 v8, v44, v44
    v_mul_f32 v9, v45, v45
    v_mul_f32 v10, v46, v46
    v_mul_f32 v11, v47, v47
    v_mov_b32 v12, s56
    v_fmac_f32 v12, s57, v8
    v_mov_b32 v13, s56
    v_fmac_f32 v13, s57, v9
    v_mov_b32 v14, s56
    v_fmac_f32 v14, s57, v10
    v_mov_b32 v15, s56
    v_fmac_f32 v15, s57, v11
    v_mul_f32 v8, v12, v44
    v_mul_f32 v9, v13, v45
    v_mul_f32 v10, v14, v46
    v_mul_f32 v11, v15, v47
    v_exp_f32 v8, -v8
    v_exp_f32 v9, -v9
    v_exp_f32 v10, -v10
    v_exp_f32 v11, -v11
    v_add_f32 v8, 1.0, v8
    v_add_f32 v9, 1.0, v9
    v_add_f32 v10, 1.0, v10
    v_add_f32 v11, 1.0, v11
    v_rcp_f32 v8, v8
    v_rcp_f32 v9, v9
    v_rcp_f32 v10, v10
    v_rcp_f32 v11, v11
    v_mul_f32 v44, v44, v8
    v_mul_f32 v45, v45, v9
    v_mul_f32 v46, v46, v10
    v_mul_f32 v47, v47, v11
    v_cvt_pk_bf16_f32 v44, v44, v45
    v_cvt_pk_bf16_f32 v45, v46, v47
    ds_write_b64 v7, v[44:45] offset:3840
    v_add_f32 v48, v48, v180
    v_add_f32 v49, v49, v181
    v_add_f32 v50, v50, v182
    v_add_f32 v51, v51, v183
    v_mul_f32 v8, v48, v48
    v_mul_f32 v9, v49, v49
    v_mul_f32 v10, v50, v50
    v_mul_f32 v11, v51, v51
    v_mov_b32 v12, s56
    v_fmac_f32 v12, s57, v8
    v_mov_b32 v13, s56
    v_fmac_f32 v13, s57, v9
    v_mov_b32 v14, s56
    v_fmac_f32 v14, s57, v10
    v_mov_b32 v15, s56
    v_fmac_f32 v15, s57, v11
    v_mul_f32 v8, v12, v48
    v_mul_f32 v9, v13, v49
    v_mul_f32 v10, v14, v50
    v_mul_f32 v11, v15, v51
    v_exp_f32 v8, -v8
    v_exp_f32 v9, -v9
    v_exp_f32 v10, -v10
    v_exp_f32 v11, -v11
    v_add_f32 v8, 1.0, v8
    v_add_f32 v9, 1.0, v9
    v_add_f32 v10, 1.0, v10
    v_add_f32 v11, 1.0, v11
    v_rcp_f32 v8, v8
    v_rcp_f32 v9, v9
    v_rcp_f32 v10, v10
    v_rcp_f32 v11, v11
    v_mul_f32 v48, v48, v8
    v_mul_f32 v49, v49, v9
    v_mul_f32 v50, v50, v10
    v_mul_f32 v51, v51, v11
    v_cvt_pk_bf16_f32 v48, v48, v49
    v_cvt_pk_bf16_f32 v49, v50, v51
    ds_write_b64 v7, v[48:49] offset:3872
    v_add_f32 v52, v52, v184
    v_add_f32 v53, v53, v185
    v_add_f32 v54, v54, v186
    v_add_f32 v55, v55, v187
    v_mul_f32 v8, v52, v52
    v_mul_f32 v9, v53, v53
    v_mul_f32 v10, v54, v54
    v_mul_f32 v11, v55, v55
    v_mov_b32 v12, s56
    v_fmac_f32 v12, s57, v8
    v_mov_b32 v13, s56
    v_fmac_f32 v13, s57, v9
    v_mov_b32 v14, s56
    v_fmac_f32 v14, s57, v10
    v_mov_b32 v15, s56
    v_fmac_f32 v15, s57, v11
    v_mul_f32 v8, v12, v52
    v_mul_f32 v9, v13, v53
    v_mul_f32 v10, v14, v54
    v_mul_f32 v11, v15, v55
    v_exp_f32 v8, -v8
    v_exp_f32 v9, -v9
    v_exp_f32 v10, -v10
    v_exp_f32 v11, -v11
    v_add_f32 v8, 1.0, v8
    v_add_f32 v9, 1.0, v9
    v_add_f32 v10, 1.0, v10
    v_add_f32 v11, 1.0, v11
    v_rcp_f32 v8, v8
    v_rcp_f32 v9, v9
    v_rcp_f32 v10, v10
    v_rcp_f32 v11, v11
    v_mul_f32 v52, v52, v8
    v_mul_f32 v53, v53, v9
    v_mul_f32 v54, v54, v10
    v_mul_f32 v55, v55, v11
    v_cvt_pk_bf16_f32 v52, v52, v53
    v_cvt_pk_bf16_f32 v53, v54, v55
    ds_write_b64 v7, v[52:53] offset:3904
    v_add_f32 v56, v56, v188
    v_add_f32 v57, v57, v189
    v_add_f32 v58, v58, v190
    v_add_f32 v59, v59, v191
    v_mul_f32 v8, v56, v56
    v_mul_f32 v9, v57, v57
    v_mul_f32 v10, v58, v58
    v_mul_f32 v11, v59, v59
    v_mov_b32 v12, s56
    v_fmac_f32 v12, s57, v8
    v_mov_b32 v13, s56
    v_fmac_f32 v13, s57, v9
    v_mov_b32 v14, s56
    v_fmac_f32 v14, s57, v10
    v_mov_b32 v15, s56
    v_fmac_f32 v15, s57, v11
    v_mul_f32 v8, v12, v56
    v_mul_f32 v9, v13, v57
    v_mul_f32 v10, v14, v58
    v_mul_f32 v11, v15, v59
    v_exp_f32 v8, -v8
    v_exp_f32 v9, -v9
    v_exp_f32 v10, -v10
    v_exp_f32 v11, -v11
    v_add_f32 v8, 1.0, v8
    v_add_f32 v9, 1.0, v9
    v_add_f32 v10, 1.0, v10
    v_add_f32 v11, 1.0, v11
    v_rcp_f32 v8, v8
    v_rcp_f32 v9, v9
    v_rcp_f32 v10, v10
    v_rcp_f32 v11, v11
    v_mul_f32 v56, v56, v8
    v_mul_f32 v57, v57, v9
    v_mul_f32 v58, v58, v10
    v_mul_f32 v59, v59, v11
    v_cvt_pk_bf16_f32 v56, v56, v57
    v_cvt_pk_bf16_f32 v57, v58, v59
    ds_write_b64 v7, v[56:57] offset:3936
    v_add_f32 v60, v60, v192
    v_add_f32 v61, v61, v193
    v_add_f32 v62, v62, v194
    v_add_f32 v63, v63, v195
    v_mul_f32 v8, v60, v60
    v_mul_f32 v9, v61, v61
    v_mul_f32 v10, v62, v62
    v_mul_f32 v11, v63, v63
    v_mov_b32 v12, s56
    v_fmac_f32 v12, s57, v8
    v_mov_b32 v13, s56
    v_fmac_f32 v13, s57, v9
    v_mov_b32 v14, s56
    v_fmac_f32 v14, s57, v10
    v_mov_b32 v15, s56
    v_fmac_f32 v15, s57, v11
    v_mul_f32 v8, v12, v60
    v_mul_f32 v9, v13, v61
    v_mul_f32 v10, v14, v62
    v_mul_f32 v11, v15, v63
    v_exp_f32 v8, -v8
    v_exp_f32 v9, -v9
    v_exp_f32 v10, -v10
    v_exp_f32 v11, -v11
    v_add_f32 v8, 1.0, v8
    v_add_f32 v9, 1.0, v9
    v_add_f32 v10, 1.0, v10
    v_add_f32 v11, 1.0, v11
    v_rcp_f32 v8, v8
    v_rcp_f32 v9, v9
    v_rcp_f32 v10, v10
    v_rcp_f32 v11, v11
    v_mul_f32 v60, v60, v8
    v_mul_f32 v61, v61, v9
    v_mul_f32 v62, v62, v10
    v_mul_f32 v63, v63, v11
    v_cvt_pk_bf16_f32 v60, v60, v61
    v_cvt_pk_bf16_f32 v61, v62, v63
    ds_write_b64 v7, v[60:61] offset:3968
    v_add_f32 v64, v64, v196
    v_add_f32 v65, v65, v197
    v_add_f32 v66, v66, v198
    v_add_f32 v67, v67, v199
    v_mul_f32 v8, v64, v64
    v_mul_f32 v9, v65, v65
    v_mul_f32 v10, v66, v66
    v_mul_f32 v11, v67, v67
    v_mov_b32 v12, s56
    v_fmac_f32 v12, s57, v8
    v_mov_b32 v13, s56
    v_fmac_f32 v13, s57, v9
    v_mov_b32 v14, s56
    v_fmac_f32 v14, s57, v10
    v_mov_b32 v15, s56
    v_fmac_f32 v15, s57, v11
    v_mul_f32 v8, v12, v64
    v_mul_f32 v9, v13, v65
    v_mul_f32 v10, v14, v66
    v_mul_f32 v11, v15, v67
    v_exp_f32 v8, -v8
    v_exp_f32 v9, -v9
    v_exp_f32 v10, -v10
    v_exp_f32 v11, -v11
    v_add_f32 v8, 1.0, v8
    v_add_f32 v9, 1.0, v9
    v_add_f32 v10, 1.0, v10
    v_add_f32 v11, 1.0, v11
    v_rcp_f32 v8, v8
    v_rcp_f32 v9, v9
    v_rcp_f32 v10, v10
    v_rcp_f32 v11, v11
    v_mul_f32 v64, v64, v8
    v_mul_f32 v65, v65, v9
    v_mul_f32 v66, v66, v10
    v_mul_f32 v67, v67, v11
    v_cvt_pk_bf16_f32 v64, v64, v65
    v_cvt_pk_bf16_f32 v65, v66, v67
    ds_write_b64 v7, v[64:65] offset:4000
    v_add_f32 v68, v68, v200
    v_add_f32 v69, v69, v201
    v_add_f32 v70, v70, v202
    v_add_f32 v71, v71, v203
    v_mul_f32 v8, v68, v68
    v_mul_f32 v9, v69, v69
    v_mul_f32 v10, v70, v70
    v_mul_f32 v11, v71, v71
    v_mov_b32 v12, s56
    v_fmac_f32 v12, s57, v8
    v_mov_b32 v13, s56
    v_fmac_f32 v13, s57, v9
    v_mov_b32 v14, s56
    v_fmac_f32 v14, s57, v10
    v_mov_b32 v15, s56
    v_fmac_f32 v15, s57, v11
    v_mul_f32 v8, v12, v68
    v_mul_f32 v9, v13, v69
    v_mul_f32 v10, v14, v70
    v_mul_f32 v11, v15, v71
    v_exp_f32 v8, -v8
    v_exp_f32 v9, -v9
    v_exp_f32 v10, -v10
    v_exp_f32 v11, -v11
    v_add_f32 v8, 1.0, v8
    v_add_f32 v9, 1.0, v9
    v_add_f32 v10, 1.0, v10
    v_add_f32 v11, 1.0, v11
    v_rcp_f32 v8, v8
    v_rcp_f32 v9, v9
    v_rcp_f32 v10, v10
    v_rcp_f32 v11, v11
    v_mul_f32 v68, v68, v8
    v_mul_f32 v69, v69, v9
    v_mul_f32 v70, v70, v10
    v_mul_f32 v71, v71, v11
    v_cvt_pk_bf16_f32 v68, v68, v69
    v_cvt_pk_bf16_f32 v69, v70, v71
    ds_write_b64 v7, v[68:69] offset:4032
    v_add_f32 v72, v72, v176
    v_add_f32 v73, v73, v177
    v_add_f32 v74, v74, v178
    v_add_f32 v75, v75, v179
    v_mul_f32 v8, v72, v72
    v_mul_f32 v9, v73, v73
    v_mul_f32 v10, v74, v74
    v_mul_f32 v11, v75, v75
    v_mov_b32 v12, s56
    v_fmac_f32 v12, s57, v8
    v_mov_b32 v13, s56
    v_fmac_f32 v13, s57, v9
    v_mov_b32 v14, s56
    v_fmac_f32 v14, s57, v10
    v_mov_b32 v15, s56
    v_fmac_f32 v15, s57, v11
    v_mul_f32 v8, v12, v72
    v_mul_f32 v9, v13, v73
    v_mul_f32 v10, v14, v74
    v_mul_f32 v11, v15, v75
    v_exp_f32 v8, -v8
    v_exp_f32 v9, -v9
    v_exp_f32 v10, -v10
    v_exp_f32 v11, -v11
    v_add_f32 v8, 1.0, v8
    v_add_f32 v9, 1.0, v9
    v_add_f32 v10, 1.0, v10
    v_add_f32 v11, 1.0, v11
    v_rcp_f32 v8, v8
    v_rcp_f32 v9, v9
    v_rcp_f32 v10, v10
    v_rcp_f32 v11, v11
    v_mul_f32 v72, v72, v8
    v_mul_f32 v73, v73, v9
    v_mul_f32 v74, v74, v10
    v_mul_f32 v75, v75, v11
    v_cvt_pk_bf16_f32 v72, v72, v73
    v_cvt_pk_bf16_f32 v73, v74, v75
    ds_write_b64 v7, v[72:73] offset:7680
    v_add_f32 v76, v76, v180
    v_add_f32 v77, v77, v181
    v_add_f32 v78, v78, v182
    v_add_f32 v79, v79, v183
    v_mul_f32 v8, v76, v76
    v_mul_f32 v9, v77, v77
    v_mul_f32 v10, v78, v78
    v_mul_f32 v11, v79, v79
    v_mov_b32 v12, s56
    v_fmac_f32 v12, s57, v8
    v_mov_b32 v13, s56
    v_fmac_f32 v13, s57, v9
    v_mov_b32 v14, s56
    v_fmac_f32 v14, s57, v10
    v_mov_b32 v15, s56
    v_fmac_f32 v15, s57, v11
    v_mul_f32 v8, v12, v76
    v_mul_f32 v9, v13, v77
    v_mul_f32 v10, v14, v78
    v_mul_f32 v11, v15, v79
    v_exp_f32 v8, -v8
    v_exp_f32 v9, -v9
    v_exp_f32 v10, -v10
    v_exp_f32 v11, -v11
    v_add_f32 v8, 1.0, v8
    v_add_f32 v9, 1.0, v9
    v_add_f32 v10, 1.0, v10
    v_add_f32 v11, 1.0, v11
    v_rcp_f32 v8, v8
    v_rcp_f32 v9, v9
    v_rcp_f32 v10, v10
    v_rcp_f32 v11, v11
    v_mul_f32 v76, v76, v8
    v_mul_f32 v77, v77, v9
    v_mul_f32 v78, v78, v10
    v_mul_f32 v79, v79, v11
    v_cvt_pk_bf16_f32 v76, v76, v77
    v_cvt_pk_bf16_f32 v77, v78, v79
    ds_write_b64 v7, v[76:77] offset:7712
    v_add_f32 v80, v80, v184
    v_add_f32 v81, v81, v185
    v_add_f32 v82, v82, v186
    v_add_f32 v83, v83, v187
    v_mul_f32 v8, v80, v80
    v_mul_f32 v9, v81, v81
    v_mul_f32 v10, v82, v82
    v_mul_f32 v11, v83, v83
    v_mov_b32 v12, s56
    v_fmac_f32 v12, s57, v8
    v_mov_b32 v13, s56
    v_fmac_f32 v13, s57, v9
    v_mov_b32 v14, s56
    v_fmac_f32 v14, s57, v10
    v_mov_b32 v15, s56
    v_fmac_f32 v15, s57, v11
    v_mul_f32 v8, v12, v80
    v_mul_f32 v9, v13, v81
    v_mul_f32 v10, v14, v82
    v_mul_f32 v11, v15, v83
    v_exp_f32 v8, -v8
    v_exp_f32 v9, -v9
    v_exp_f32 v10, -v10
    v_exp_f32 v11, -v11
    v_add_f32 v8, 1.0, v8
    v_add_f32 v9, 1.0, v9
    v_add_f32 v10, 1.0, v10
    v_add_f32 v11, 1.0, v11
    v_rcp_f32 v8, v8
    v_rcp_f32 v9, v9
    v_rcp_f32 v10, v10
    v_rcp_f32 v11, v11
    v_mul_f32 v80, v80, v8
    v_mul_f32 v81, v81, v9
    v_mul_f32 v82, v82, v10
    v_mul_f32 v83, v83, v11
    v_cvt_pk_bf16_f32 v80, v80, v81
    v_cvt_pk_bf16_f32 v81, v82, v83
    ds_write_b64 v7, v[80:81] offset:7744
    v_add_f32 v84, v84, v188
    v_add_f32 v85, v85, v189
    v_add_f32 v86, v86, v190
    v_add_f32 v87, v87, v191
    v_mul_f32 v8, v84, v84
    v_mul_f32 v9, v85, v85
    v_mul_f32 v10, v86, v86
    v_mul_f32 v11, v87, v87
    v_mov_b32 v12, s56
    v_fmac_f32 v12, s57, v8
    v_mov_b32 v13, s56
    v_fmac_f32 v13, s57, v9
    v_mov_b32 v14, s56
    v_fmac_f32 v14, s57, v10
    v_mov_b32 v15, s56
    v_fmac_f32 v15, s57, v11
    v_mul_f32 v8, v12, v84
    v_mul_f32 v9, v13, v85
    v_mul_f32 v10, v14, v86
    v_mul_f32 v11, v15, v87
    v_exp_f32 v8, -v8
    v_exp_f32 v9, -v9
    v_exp_f32 v10, -v10
    v_exp_f32 v11, -v11
    v_add_f32 v8, 1.0, v8
    v_add_f32 v9, 1.0, v9
    v_add_f32 v10, 1.0, v10
    v_add_f32 v11, 1.0, v11
    v_rcp_f32 v8, v8
    v_rcp_f32 v9, v9
    v_rcp_f32 v10, v10
    v_rcp_f32 v11, v11
    v_mul_f32 v84, v84, v8
    v_mul_f32 v85, v85, v9
    v_mul_f32 v86, v86, v10
    v_mul_f32 v87, v87, v11
    v_cvt_pk_bf16_f32 v84, v84, v85
    v_cvt_pk_bf16_f32 v85, v86, v87
    ds_write_b64 v7, v[84:85] offset:7776
    v_add_f32 v88, v88, v192
    v_add_f32 v89, v89, v193
    v_add_f32 v90, v90, v194
    v_add_f32 v91, v91, v195
    v_mul_f32 v8, v88, v88
    v_mul_f32 v9, v89, v89
    v_mul_f32 v10, v90, v90
    v_mul_f32 v11, v91, v91
    v_mov_b32 v12, s56
    v_fmac_f32 v12, s57, v8
    v_mov_b32 v13, s56
    v_fmac_f32 v13, s57, v9
    v_mov_b32 v14, s56
    v_fmac_f32 v14, s57, v10
    v_mov_b32 v15, s56
    v_fmac_f32 v15, s57, v11
    v_mul_f32 v8, v12, v88
    v_mul_f32 v9, v13, v89
    v_mul_f32 v10, v14, v90
    v_mul_f32 v11, v15, v91
    v_exp_f32 v8, -v8
    v_exp_f32 v9, -v9
    v_exp_f32 v10, -v10
    v_exp_f32 v11, -v11
    v_add_f32 v8, 1.0, v8
    v_add_f32 v9, 1.0, v9
    v_add_f32 v10, 1.0, v10
    v_add_f32 v11, 1.0, v11
    v_rcp_f32 v8, v8
    v_rcp_f32 v9, v9
    v_rcp_f32 v10, v10
    v_rcp_f32 v11, v11
    v_mul_f32 v88, v88, v8
    v_mul_f32 v89, v89, v9
    v_mul_f32 v90, v90, v10
    v_mul_f32 v91, v91, v11
    v_cvt_pk_bf16_f32 v88, v88, v89
    v_cvt_pk_bf16_f32 v89, v90, v91
    ds_write_b64 v7, v[88:89] offset:7808
    v_add_f32 v92, v92, v196
    v_add_f32 v93, v93, v197
    v_add_f32 v94, v94, v198
    v_add_f32 v95, v95, v199
    v_mul_f32 v8, v92, v92
    v_mul_f32 v9, v93, v93
    v_mul_f32 v10, v94, v94
    v_mul_f32 v11, v95, v95
    v_mov_b32 v12, s56
    v_fmac_f32 v12, s57, v8
    v_mov_b32 v13, s56
    v_fmac_f32 v13, s57, v9
    v_mov_b32 v14, s56
    v_fmac_f32 v14, s57, v10
    v_mov_b32 v15, s56
    v_fmac_f32 v15, s57, v11
    v_mul_f32 v8, v12, v92
    v_mul_f32 v9, v13, v93
    v_mul_f32 v10, v14, v94
    v_mul_f32 v11, v15, v95
    v_exp_f32 v8, -v8
    v_exp_f32 v9, -v9
    v_exp_f32 v10, -v10
    v_exp_f32 v11, -v11
    v_add_f32 v8, 1.0, v8
    v_add_f32 v9, 1.0, v9
    v_add_f32 v10, 1.0, v10
    v_add_f32 v11, 1.0, v11
    v_rcp_f32 v8, v8
    v_rcp_f32 v9, v9
    v_rcp_f32 v10, v10
    v_rcp_f32 v11, v11
    v_mul_f32 v92, v92, v8
    v_mul_f32 v93, v93, v9
    v_mul_f32 v94, v94, v10
    v_mul_f32 v95, v95, v11
    v_cvt_pk_bf16_f32 v92, v92, v93
    v_cvt_pk_bf16_f32 v93, v94, v95
    ds_write_b64 v7, v[92:93] offset:7840
    v_add_f32 v96, v96, v200
    v_add_f32 v97, v97, v201
    v_add_f32 v98, v98, v202
    v_add_f32 v99, v99, v203
    v_mul_f32 v8, v96, v96
    v_mul_f32 v9, v97, v97
    v_mul_f32 v10, v98, v98
    v_mul_f32 v11, v99, v99
    v_mov_b32 v12, s56
    v_fmac_f32 v12, s57, v8
    v_mov_b32 v13, s56
    v_fmac_f32 v13, s57, v9
    v_mov_b32 v14, s56
    v_fmac_f32 v14, s57, v10
    v_mov_b32 v15, s56
    v_fmac_f32 v15, s57, v11
    v_mul_f32 v8, v12, v96
    v_mul_f32 v9, v13, v97
    v_mul_f32 v10, v14, v98
    v_mul_f32 v11, v15, v99
    v_exp_f32 v8, -v8
    v_exp_f32 v9, -v9
    v_exp_f32 v10, -v10
    v_exp_f32 v11, -v11
    v_add_f32 v8, 1.0, v8
    v_add_f32 v9, 1.0, v9
    v_add_f32 v10, 1.0, v10
    v_add_f32 v11, 1.0, v11
    v_rcp_f32 v8, v8
    v_rcp_f32 v9, v9
    v_rcp_f32 v10, v10
    v_rcp_f32 v11, v11
    v_mul_f32 v96, v96, v8
    v_mul_f32 v97, v97, v9
    v_mul_f32 v98, v98, v10
    v_mul_f32 v99, v99, v11
    v_cvt_pk_bf16_f32 v96, v96, v97
    v_cvt_pk_bf16_f32 v97, v98, v99
    ds_write_b64 v7, v[96:97] offset:7872
    v_add_f32 v100, v100, v176
    v_add_f32 v101, v101, v177
    v_add_f32 v102, v102, v178
    v_add_f32 v103, v103, v179
    v_mul_f32 v8, v100, v100
    v_mul_f32 v9, v101, v101
    v_mul_f32 v10, v102, v102
    v_mul_f32 v11, v103, v103
    v_mov_b32 v12, s56
    v_fmac_f32 v12, s57, v8
    v_mov_b32 v13, s56
    v_fmac_f32 v13, s57, v9
    v_mov_b32 v14, s56
    v_fmac_f32 v14, s57, v10
    v_mov_b32 v15, s56
    v_fmac_f32 v15, s57, v11
    v_mul_f32 v8, v12, v100
    v_mul_f32 v9, v13, v101
    v_mul_f32 v10, v14, v102
    v_mul_f32 v11, v15, v103
    v_exp_f32 v8, -v8
    v_exp_f32 v9, -v9
    v_exp_f32 v10, -v10
    v_exp_f32 v11, -v11
    v_add_f32 v8, 1.0, v8
    v_add_f32 v9, 1.0, v9
    v_add_f32 v10, 1.0, v10
    v_add_f32 v11, 1.0, v11
    v_rcp_f32 v8, v8
    v_rcp_f32 v9, v9
    v_rcp_f32 v10, v10
    v_rcp_f32 v11, v11
    v_mul_f32 v100, v100, v8
    v_mul_f32 v101, v101, v9
    v_mul_f32 v102, v102, v10
    v_mul_f32 v103, v103, v11
    v_cvt_pk_bf16_f32 v100, v100, v101
    v_cvt_pk_bf16_f32 v101, v102, v103
    ds_write_b64 v7, v[100:101] offset:11520
    v_add_f32 v104, v104, v180
    v_add_f32 v105, v105, v181
    v_add_f32 v106, v106, v182
    v_add_f32 v107, v107, v183
    v_mul_f32 v8, v104, v104
    v_mul_f32 v9, v105, v105
    v_mul_f32 v10, v106, v106
    v_mul_f32 v11, v107, v107
    v_mov_b32 v12, s56
    v_fmac_f32 v12, s57, v8
    v_mov_b32 v13, s56
    v_fmac_f32 v13, s57, v9
    v_mov_b32 v14, s56
    v_fmac_f32 v14, s57, v10
    v_mov_b32 v15, s56
    v_fmac_f32 v15, s57, v11
    v_mul_f32 v8, v12, v104
    v_mul_f32 v9, v13, v105
    v_mul_f32 v10, v14, v106
    v_mul_f32 v11, v15, v107
    v_exp_f32 v8, -v8
    v_exp_f32 v9, -v9
    v_exp_f32 v10, -v10
    v_exp_f32 v11, -v11
    v_add_f32 v8, 1.0, v8
    v_add_f32 v9, 1.0, v9
    v_add_f32 v10, 1.0, v10
    v_add_f32 v11, 1.0, v11
    v_rcp_f32 v8, v8
    v_rcp_f32 v9, v9
    v_rcp_f32 v10, v10
    v_rcp_f32 v11, v11
    v_mul_f32 v104, v104, v8
    v_mul_f32 v105, v105, v9
    v_mul_f32 v106, v106, v10
    v_mul_f32 v107, v107, v11
    v_cvt_pk_bf16_f32 v104, v104, v105
    v_cvt_pk_bf16_f32 v105, v106, v107
    ds_write_b64 v7, v[104:105] offset:11552
    v_add_f32 v108, v108, v184
    v_add_f32 v109, v109, v185
    v_add_f32 v110, v110, v186
    v_add_f32 v111, v111, v187
    v_mul_f32 v8, v108, v108
    v_mul_f32 v9, v109, v109
    v_mul_f32 v10, v110, v110
    v_mul_f32 v11, v111, v111
    v_mov_b32 v12, s56
    v_fmac_f32 v12, s57, v8
    v_mov_b32 v13, s56
    v_fmac_f32 v13, s57, v9
    v_mov_b32 v14, s56
    v_fmac_f32 v14, s57, v10
    v_mov_b32 v15, s56
    v_fmac_f32 v15, s57, v11
    v_mul_f32 v8, v12, v108
    v_mul_f32 v9, v13, v109
    v_mul_f32 v10, v14, v110
    v_mul_f32 v11, v15, v111
    v_exp_f32 v8, -v8
    v_exp_f32 v9, -v9
    v_exp_f32 v10, -v10
    v_exp_f32 v11, -v11
    v_add_f32 v8, 1.0, v8
    v_add_f32 v9, 1.0, v9
    v_add_f32 v10, 1.0, v10
    v_add_f32 v11, 1.0, v11
    v_rcp_f32 v8, v8
    v_rcp_f32 v9, v9
    v_rcp_f32 v10, v10
    v_rcp_f32 v11, v11
    v_mul_f32 v108, v108, v8
    v_mul_f32 v109, v109, v9
    v_mul_f32 v110, v110, v10
    v_mul_f32 v111, v111, v11
    v_cvt_pk_bf16_f32 v108, v108, v109
    v_cvt_pk_bf16_f32 v109, v110, v111
    ds_write_b64 v7, v[108:109] offset:11584
    v_add_f32 v112, v112, v188
    v_add_f32 v113, v113, v189
    v_add_f32 v114, v114, v190
    v_add_f32 v115, v115, v191
    v_mul_f32 v8, v112, v112
    v_mul_f32 v9, v113, v113
    v_mul_f32 v10, v114, v114
    v_mul_f32 v11, v115, v115
    v_mov_b32 v12, s56
    v_fmac_f32 v12, s57, v8
    v_mov_b32 v13, s56
    v_fmac_f32 v13, s57, v9
    v_mov_b32 v14, s56
    v_fmac_f32 v14, s57, v10
    v_mov_b32 v15, s56
    v_fmac_f32 v15, s57, v11
    v_mul_f32 v8, v12, v112
    v_mul_f32 v9, v13, v113
    v_mul_f32 v10, v14, v114
    v_mul_f32 v11, v15, v115
    v_exp_f32 v8, -v8
    v_exp_f32 v9, -v9
    v_exp_f32 v10, -v10
    v_exp_f32 v11, -v11
    v_add_f32 v8, 1.0, v8
    v_add_f32 v9, 1.0, v9
    v_add_f32 v10, 1.0, v10
    v_add_f32 v11, 1.0, v11
    v_rcp_f32 v8, v8
    v_rcp_f32 v9, v9
    v_rcp_f32 v10, v10
    v_rcp_f32 v11, v11
    v_mul_f32 v112, v112, v8
    v_mul_f32 v113, v113, v9
    v_mul_f32 v114, v114, v10
    v_mul_f32 v115, v115, v11
    v_cvt_pk_bf16_f32 v112, v112, v113
    v_cvt_pk_bf16_f32 v113, v114, v115
    ds_write_b64 v7, v[112:113] offset:11616
    v_add_f32 v116, v116, v192
    v_add_f32 v117, v117, v193
    v_add_f32 v118, v118, v194
    v_add_f32 v119, v119, v195
    v_mul_f32 v8, v116, v116
    v_mul_f32 v9, v117, v117
    v_mul_f32 v10, v118, v118
    v_mul_f32 v11, v119, v119
    v_mov_b32 v12, s56
    v_fmac_f32 v12, s57, v8
    v_mov_b32 v13, s56
    v_fmac_f32 v13, s57, v9
    v_mov_b32 v14, s56
    v_fmac_f32 v14, s57, v10
    v_mov_b32 v15, s56
    v_fmac_f32 v15, s57, v11
    v_mul_f32 v8, v12, v116
    v_mul_f32 v9, v13, v117
    v_mul_f32 v10, v14, v118
    v_mul_f32 v11, v15, v119
    v_exp_f32 v8, -v8
    v_exp_f32 v9, -v9
    v_exp_f32 v10, -v10
    v_exp_f32 v11, -v11
    v_add_f32 v8, 1.0, v8
    v_add_f32 v9, 1.0, v9
    v_add_f32 v10, 1.0, v10
    v_add_f32 v11, 1.0, v11
    v_rcp_f32 v8, v8
    v_rcp_f32 v9, v9
    v_rcp_f32 v10, v10
    v_rcp_f32 v11, v11
    v_mul_f32 v116, v116, v8
    v_mul_f32 v117, v117, v9
    v_mul_f32 v118, v118, v10
    v_mul_f32 v119, v119, v11
    v_cvt_pk_bf16_f32 v116, v116, v117
    v_cvt_pk_bf16_f32 v117, v118, v119
    ds_write_b64 v7, v[116:117] offset:11648
    v_add_f32 v120, v120, v196
    v_add_f32 v121, v121, v197
    v_add_f32 v122, v122, v198
    v_add_f32 v123, v123, v199
    v_mul_f32 v8, v120, v120
    v_mul_f32 v9, v121, v121
    v_mul_f32 v10, v122, v122
    v_mul_f32 v11, v123, v123
    v_mov_b32 v12, s56
    v_fmac_f32 v12, s57, v8
    v_mov_b32 v13, s56
    v_fmac_f32 v13, s57, v9
    v_mov_b32 v14, s56
    v_fmac_f32 v14, s57, v10
    v_mov_b32 v15, s56
    v_fmac_f32 v15, s57, v11
    v_mul_f32 v8, v12, v120
    v_mul_f32 v9, v13, v121
    v_mul_f32 v10, v14, v122
    v_mul_f32 v11, v15, v123
    v_exp_f32 v8, -v8
    v_exp_f32 v9, -v9
    v_exp_f32 v10, -v10
    v_exp_f32 v11, -v11
    v_add_f32 v8, 1.0, v8
    v_add_f32 v9, 1.0, v9
    v_add_f32 v10, 1.0, v10
    v_add_f32 v11, 1.0, v11
    v_rcp_f32 v8, v8
    v_rcp_f32 v9, v9
    v_rcp_f32 v10, v10
    v_rcp_f32 v11, v11
    v_mul_f32 v120, v120, v8
    v_mul_f32 v121, v121, v9
    v_mul_f32 v122, v122, v10
    v_mul_f32 v123, v123, v11
    v_cvt_pk_bf16_f32 v120, v120, v121
    v_cvt_pk_bf16_f32 v121, v122, v123
    ds_write_b64 v7, v[120:121] offset:11680
    v_add_f32 v124, v124, v200
    v_add_f32 v125, v125, v201
    v_add_f32 v126, v126, v202
    v_add_f32 v127, v127, v203
    v_mul_f32 v8, v124, v124
    v_mul_f32 v9, v125, v125
    v_mul_f32 v10, v126, v126
    v_mul_f32 v11, v127, v127
    v_mov_b32 v12, s56
    v_fmac_f32 v12, s57, v8
    v_mov_b32 v13, s56
    v_fmac_f32 v13, s57, v9
    v_mov_b32 v14, s56
    v_fmac_f32 v14, s57, v10
    v_mov_b32 v15, s56
    v_fmac_f32 v15, s57, v11
    v_mul_f32 v8, v12, v124
    v_mul_f32 v9, v13, v125
    v_mul_f32 v10, v14, v126
    v_mul_f32 v11, v15, v127
    v_exp_f32 v8, -v8
    v_exp_f32 v9, -v9
    v_exp_f32 v10, -v10
    v_exp_f32 v11, -v11
    v_add_f32 v8, 1.0, v8
    v_add_f32 v9, 1.0, v9
    v_add_f32 v10, 1.0, v10
    v_add_f32 v11, 1.0, v11
    v_rcp_f32 v8, v8
    v_rcp_f32 v9, v9
    v_rcp_f32 v10, v10
    v_rcp_f32 v11, v11
    v_mul_f32 v124, v124, v8
    v_mul_f32 v125, v125, v9
    v_mul_f32 v126, v126, v10
    v_mul_f32 v127, v127, v11
    v_cvt_pk_bf16_f32 v124, v124, v125
    v_cvt_pk_bf16_f32 v125, v126, v127
    ds_write_b64 v7, v[124:125] offset:11712
    s_waitcnt lgkmcnt(0)
    v_lshrrev_b32 v8, 4, v1
    v_and_b32 v9, 15, v1
    v_mul_u32_u24 v10, 240, v8
    v_lshl_add_u32 v10, v9, 4, v10
    v_add_u32 v10, s58, v10
    s_lshl_b32 s40, s27, 7
    s_lshl_b32 s41, s25, 6
    s_add_u32 s40, s40, s41
    v_add_u32 v8, s40, v8
    v_mul_u32_u24 v8, 7168, v8
    s_mul_i32 s40, s28, 448
    s_mul_i32 s41, s26, 224
    s_add_u32 s40, s40, s41
    v_lshl_add_u32 v8, v9, 4, v8
    v_add_u32 v8, s40, v8
    v_cmp_gt_u32 vcc, 14, v9
    v_mov_b32 v11, 0x7ffffff0
    s_nop 1
    v_cndmask_b32 v8, v11, v8, vcc
    ds_read_b128 v[128:131], v10 offset:0
    ds_read_b128 v[132:135], v10 offset:960
    ds_read_b128 v[136:139], v10 offset:1920
    ds_read_b128 v[140:143], v10 offset:2880
    ds_read_b128 v[144:147], v10 offset:3840
    ds_read_b128 v[148:151], v10 offset:4800
    ds_read_b128 v[152:155], v10 offset:5760
    ds_read_b128 v[156:159], v10 offset:6720
    ds_read_b128 v[160:163], v10 offset:7680
    ds_read_b128 v[164:167], v10 offset:8640
    ds_read_b128 v[168:171], v10 offset:9600
    ds_read_b128 v[172:175], v10 offset:10560
    ds_read_b128 v[176:179], v10 offset:11520
    ds_read_b128 v[180:183], v10 offset:12480
    ds_read_b128 v[184:187], v10 offset:13440
    ds_read_b128 v[188:191], v10 offset:14400
    s_mov_b32 s40, 0
    s_waitcnt lgkmcnt(15)
    buffer_store_dwordx4 v[128:131], v8, s[52:55], s40 offen
    s_mov_b32 s40, 28672
    s_waitcnt lgkmcnt(14)
    buffer_store_dwordx4 v[132:135], v8, s[52:55], s40 offen
    s_mov_b32 s40, 57344
    s_waitcnt lgkmcnt(13)
    buffer_store_dwordx4 v[136:139], v8, s[52:55], s40 offen
    s_mov_b32 s40, 86016
    s_waitcnt lgkmcnt(12)
    buffer_store_dwordx4 v[140:143], v8, s[52:55], s40 offen
    s_mov_b32 s40, 114688
    s_waitcnt lgkmcnt(11)
    buffer_store_dwordx4 v[144:147], v8, s[52:55], s40 offen
    s_mov_b32 s40, 143360
    s_waitcnt lgkmcnt(10)
    buffer_store_dwordx4 v[148:151], v8, s[52:55], s40 offen
    s_mov_b32 s40, 172032
    s_waitcnt lgkmcnt(9)
    buffer_store_dwordx4 v[152:155], v8, s[52:55], s40 offen
    s_mov_b32 s40, 200704
    s_waitcnt lgkmcnt(8)
    buffer_store_dwordx4 v[156:159], v8, s[52:55], s40 offen
    s_mov_b32 s40, 229376
    s_waitcnt lgkmcnt(7)
    buffer_store_dwordx4 v[160:163], v8, s[52:55], s40 offen
    s_mov_b32 s40, 258048
    s_waitcnt lgkmcnt(6)
    buffer_store_dwordx4 v[164:167], v8, s[52:55], s40 offen
    s_mov_b32 s40, 286720
    s_waitcnt lgkmcnt(5)
    buffer_store_dwordx4 v[168:171], v8, s[52:55], s40 offen
    s_mov_b32 s40, 315392
    s_waitcnt lgkmcnt(4)
    buffer_store_dwordx4 v[172:175], v8, s[52:55], s40 offen
    s_mov_b32 s40, 344064
    s_waitcnt lgkmcnt(3)
    buffer_store_dwordx4 v[176:179], v8, s[52:55], s40 offen
    s_mov_b32 s40, 372736
    s_waitcnt lgkmcnt(2)
    buffer_store_dwordx4 v[180:183], v8, s[52:55], s40 offen
    s_mov_b32 s40, 401408
    s_waitcnt lgkmcnt(1)
    buffer_store_dwordx4 v[184:187], v8, s[52:55], s40 offen
    s_mov_b32 s40, 430080
    s_waitcnt lgkmcnt(0)
    buffer_store_dwordx4 v[188:191], v8, s[52:55], s40 offen
L_gemm_w1_kernel_end:
    s_endpgm
.globl gemm_w2_kernel
.p2align 8
.type gemm_w2_kernel,@function
gemm_w2_kernel:
    s_cmp_ge_u32 s2, 256
    s_cbranch_scc1 L_gemm_w2_kernel_end
    s_load_dwordx2 s[4:5], s[0:1], 80
    s_load_dwordx2 s[6:7], s[0:1], 48
    v_and_b32 v1, 63, v0
    v_lshrrev_b32 v2, 6, v0
    s_nop 0
    v_readfirstlane_b32 s24, v2
    s_and_b32 s60, s24, 4
    s_and_b32 s24, s24, 3
    s_and_b32 s25, s24, 1
    s_lshr_b32 s26, s24, 1
    s_and_b32 s40, s2, 7
    s_lshr_b32 s41, s2, 3
    s_and_b32 s42, s40, 1
    s_lshl_b32 s42, s42, 3
    s_and_b32 s43, s41, 7
    s_add_u32 s27, s42, s43
    s_lshr_b32 s42, s40, 1
    s_lshl_b32 s42, s42, 2
    s_lshr_b32 s43, s41, 3
    s_add_u32 s28, s42, s43
    s_lshr_b32 s29, s28, 3
    s_and_b32 s28, s28, 7
    s_waitcnt lgkmcnt(0)
    s_add_u32 s8, s4, 16777216
    s_addc_u32 s9, s5, 0
    s_mov_b32 s10, 14680064
    s_mov_b32 s11, 0x00020000
    s_add_u32 s12, s6, 0
    s_addc_u32 s13, s7, 0
    s_mov_b32 s14, 7340032
    s_mov_b32 s15, 0x00020000
    s_cmp_eq_u32 s60, 0
    s_cbranch_scc1 L_gemm_w2_kernel_compute
    v_lshrrev_b32 v2, 3, v1
    v_and_b32 v3, 7, v1
    v_lshrrev_b32 v4, 4, v1
    s_lshl_b32 s40, s27, 7
    s_lshl_b32 s41, s24, 5
    s_add_u32 s40, s40, s41
    s_mul_i32 s44, s29, 3584
    v_xor_b32 v5, v3, v4
    v_add_u32 v6, 0, v2
    v_add_u32 v6, s40, v6
    v_mul_u32_u24 v6, 7168, v6
    v_lshl_add_u32 v220, v5, 4, v6
    v_add_u32 v220, s44, v220
    v_xor_b32 v5, v3, v4
    v_xor_b32 v5, 4, v5
    v_add_u32 v6, 8, v2
    v_add_u32 v6, s40, v6
    v_mul_u32_u24 v6, 7168, v6
    v_lshl_add_u32 v221, v5, 4, v6
    v_add_u32 v221, s44, v221
    v_xor_b32 v5, v3, v4
    v_add_u32 v6, 16, v2
    v_add_u32 v6, s40, v6
    v_mul_u32_u24 v6, 7168, v6
    v_lshl_add_u32 v222, v5, 4, v6
    v_add_u32 v222, s44, v222
    v_xor_b32 v5, v3, v4
    v_xor_b32 v5, 4, v5
    v_add_u32 v6, 24, v2
    v_add_u32 v6, s40, v6
    v_mul_u32_u24 v6, 7168, v6
    v_lshl_add_u32 v223, v5, 4, v6
    v_add_u32 v223, s44, v223
    v_lshrrev_b32 v2, 3, v1
    v_and_b32 v3, 7, v1
    v_lshrrev_b32 v5, 4, v1
    v_and_b32 v5, 1, v5
    v_lshrrev_b32 v6, 1, v3
    v_xor_b32 v6, v6, v5
    v_and_b32 v7, 1, v3
    s_mul_i32 s40, s24, 4
    s_mul_i32 s44, s29, 3670016
    s_add_u32 s41, s40, 0
    s_lshr_b32 s42, s41, 3
    s_and_b32 s43, s41, 7
    s_lshl_b32 s43, s43, 3
    s_and_b32 s45, s41, 1
    s_lshl_b32 s45, s45, 1
    v_xor_b32 v8, s45, v6
    v_lshlrev_b32 v8, 5, v8
    v_lshl_add_u32 v8, v7, 4, v8
    v_add_u32 v9, s43, v2
    v_mul_u32_u24 v9, 2048, v9
    s_mul_i32 s46, s28, 256
    s_lshl_b32 s47, s42, 7
    s_add_u32 s46, s46, s47
    s_add_u32 s46, s46, s44
    v_add_u32 v9, v9, v8
    v_add_u32 v224, s46, v9
    s_add_u32 s41, s40, 1
    s_lshr_b32 s42, s41, 3
    s_and_b32 s43, s41, 7
    s_lshl_b32 s43, s43, 3
    s_and_b32 s45, s41, 1
    s_lshl_b32 s45, s45, 1
    v_xor_b32 v8, s45, v6
    v_lshlrev_b32 v8, 5, v8
    v_lshl_add_u32 v8, v7, 4, v8
    v_add_u32 v9, s43, v2
    v_mul_u32_u24 v9, 2048, v9
    s_mul_i32 s46, s28, 256
    s_lshl_b32 s47, s42, 7
    s_add_u32 s46, s46, s47
    s_add_u32 s46, s46, s44
    v_add_u32 v9, v9, v8
    v_add_u32 v225, s46, v9
    s_add_u32 s41, s40, 2
    s_lshr_b32 s42, s41, 3
    s_and_b32 s43, s41, 7
    s_lshl_b32 s43, s43, 3
    s_and_b32 s45, s41, 1
    s_lshl_b32 s45, s45, 1
    v_xor_b32 v8, s45, v6
    v_lshlrev_b32 v8, 5, v8
    v_lshl_add_u32 v8, v7, 4, v8
    v_add_u32 v9, s43, v2
    v_mul_u32_u24 v9, 2048, v9
    s_mul_i32 s46, s28, 256
    s_lshl_b32 s47, s42, 7
    s_add_u32 s46, s46, s47
    s_add_u32 s46, s46, s44
    v_add_u32 v9, v9, v8
    v_add_u32 v226, s46, v9
    s_add_u32 s41, s40, 3
    s_lshr_b32 s42, s41, 3
    s_and_b32 s43, s41, 7
    s_lshl_b32 s43, s43, 3
    s_and_b32 s45, s41, 1
    s_lshl_b32 s45, s45, 1
    v_xor_b32 v8, s45, v6
    v_lshlrev_b32 v8, 5, v8
    v_lshl_add_u32 v8, v7, 4, v8
    v_add_u32 v9, s43, v2
    v_mul_u32_u24 v9, 2048, v9
    s_mul_i32 s46, s28, 256
    s_lshl_b32 s47, s42, 7
    s_add_u32 s46, s46, s47
    s_add_u32 s46, s46, s44
    v_add_u32 v9, v9, v8
    v_add_u32 v227, s46, v9
    s_lshl_b32 s30, s24, 12
    s_mul_i32 s31, s24, 4096
    s_add_u32 s31, s31, 16384
    s_mov_b32 s20, 0
    s_mov_b32 s21, 0
    s_mov_b32 s23, 0
    s_add_u32 m0, s23, s30
    s_nop 0
    buffer_load_dwordx4 v220, s[8:11], s20 offen lds
    s_add_u32 m0, m0, 1024
    s_nop 0
    buffer_load_dwordx4 v221, s[8:11], s20 offen lds
    s_add_u32 m0, m0, 1024
    s_nop 0
    buffer_load_dwordx4 v222, s[8:11], s20 offen lds
    s_add_u32 m0, m0, 1024
    s_nop 0
    buffer_load_dwordx4 v223, s[8:11], s20 offen lds
    s_add_u32 m0, s23, s31
    s_nop 0
    buffer_load_dwordx4 v224, s[12:15], s21 offen lds
    s_add_u32 m0, m0, 1024
    s_nop 0
    buffer_load_dwordx4 v225, s[12:15], s21 offen lds
    s_add_u32 m0, m0, 1024
    s_nop 0
    buffer_load_dwordx4 v226, s[12:15], s21 offen lds
    s_add_u32 m0, m0, 1024
    s_nop 0
    buffer_load_dwordx4 v227, s[12:15], s21 offen lds
    s_add_u32 s20, s20, 128
    s_add_u32 s21, s21, 131072
    s_add_u32 s23, s23, 32768
    s_cmp_eq_u32 s23, 98304
    s_cselect_b32 s23, 0, s23
    s_add_u32 m0, s23, s30
    s_nop 0
    buffer_load_dwordx4 v220, s[8:11], s20 offen lds
    s_add_u32 m0, m0, 1024
    s_nop 0
    buffer_load_dwordx4 v221, s[8:11], s20 offen lds
    s_add_u32 m0, m0, 1024
    s_nop 0
    buffer_load_dwordx4 v222, s[8:11], s20 offen lds
    s_add_u32 m0, m0, 1024
    s_nop 0
    buffer_load_dwordx4 v223, s[8:11], s20 offen lds
    s_add_u32 m0, s23, s31
    s_nop 0
    buffer_load_dwordx4 v224, s[12:15], s21 offen lds
    s_add_u32 m0, m0, 1024
    s_nop 0
    buffer_load_dwordx4 v225, s[12:15], s21 offen lds
    s_add_u32 m0, m0, 1024
    s_nop 0
    buffer_load_dwordx4 v226, s[12:15], s21 offen lds
    s_add_u32 m0, m0, 1024
    s_nop 0
    buffer_load_dwordx4 v227, s[12:15], s21 offen lds
    s_add_u32 s20, s20, 128
    s_add_u32 s21, s21, 131072
    s_add_u32 s23, s23, 32768
    s_cmp_eq_u32 s23, 98304
    s_cselect_b32 s23, 0, s23
    s_add_u32 m0, s23, s30
    s_nop 0
    buffer_load_dwordx4 v220, s[8:11], s20 offen lds
    s_add_u32 m0, m0, 1024
    s_nop 0
    buffer_load_dwordx4 v221, s[8:11], s20 offen lds
    s_add_u32 m0, m0, 1024
    s_nop 0
    buffer_load_dwordx4 v222, s[8:11], s20 offen lds
    s_add_u32 m0, m0, 1024
    s_nop 0
    buffer_load_dwordx4 v223, s[8:11], s20 offen lds
    s_add_u32 m0, s23, s31
    s_nop 0
    buffer_load_dwordx4 v224, s[12:15], s21 offen lds
    s_add_u32 m0, m0, 1024
    s_nop 0
    buffer_load_dwordx4 v225, s[12:15], s21 offen lds
    s_add_u32 m0, m0, 1024
    s_nop 0
    buffer_load_dwordx4 v226, s[12:15], s21 offen lds
    s_add_u32 m0, m0, 1024
    s_nop 0
    buffer_load_dwordx4 v227, s[12:15], s21 offen lds
    s_add_u32 s20, s20, 128
    s_add_u32 s21, s21, 131072
    s_add_u32 s23, s23, 32768
    s_cmp_eq_u32 s23, 98304
    s_cselect_b32 s23, 0, s23
    s_waitcnt vmcnt(16)
    s_barrier
    s_mov_b32 s22, 25
L_gemm_w2_kernel_lloop:
    s_waitcnt vmcnt(8)
    s_barrier
    s_add_u32 m0, s23, s30
    s_nop 0
    buffer_load_dwordx4 v220, s[8:11], s20 offen lds
    s_add_u32 m0, m0, 1024
    s_nop 0
    buffer_load_dwordx4 v221, s[8:11], s20 offen lds
    s_add_u32 m0, m0, 1024
    s_nop 0
    buffer_load_dwordx4 v222, s[8:11], s20 offen lds
    s_add_u32 m0, m0, 1024
    s_nop 0
    buffer_load_dwordx4 v223, s[8:11], s20 offen lds
    s_add_u32 m0, s23, s31
    s_nop 0
    buffer_load_dwordx4 v224, s[12:15], s21 offen lds
    s_add_u32 m0, m0, 1024
    s_nop 0
    buffer_load_dwordx4 v225, s[12:15], s21 offen lds
    s_add_u32 m0, m0, 1024
    s_nop 0
    buffer_load_dwordx4 v226, s[12:15], s21 offen lds
    s_add_u32 m0, m0, 1024
    s_nop 0
    buffer_load_dwordx4 v227, s[12:15], s21 offen lds
    s_add_u32 s20, s20, 128
    s_add_u32 s21, s21, 131072
    s_add_u32 s23, s23, 32768
    s_cmp_eq_u32 s23, 98304
    s_cselect_b32 s23, 0, s23
    s_sub_u32 s22, s22, 1
    s_cmp_lg_u32 s22, 0
    s_cbranch_scc1 L_gemm_w2_kernel_lloop
    s_waitcnt vmcnt(0)
    s_barrier
    s_waitcnt vmcnt(0)
    s_barrier
    s_endpgm
L_gemm_w2_kernel_compute:
    v_lshrrev_b32 v4, 4, v1
    v_and_b32 v2, 15, v1
    v_lshrrev_b32 v3, 1, v2
    s_lshl_b32 s40, s25, 13
    v_lshl_add_u32 v5, v2, 7, s40
    v_xor_b32 v6, v4, v3
    v_lshl_add_u32 v232, v6, 4, v5
    v_xor_b32 v6, 4, v6
    v_lshl_add_u32 v233, v6, 4, v5
    v_lshrrev_b32 v5, 2, v2
    v_lshl_add_u32 v6, v4, 3, v5
    v_lshlrev_b32 v6, 7, v6
    v_and_b32 v7, 3, v1
    v_lshl_add_u32 v6, v7, 3, v6
    v_add_u32 v6, 16384, v6
    v_lshrrev_b32 v5, 1, v5
    v_and_b32 v7, 1, v4
    v_lshl_add_u32 v5, v7, 1, v5
    s_mul_i32 s40, s26, 4
    s_add_u32 s40, s40, 0
    s_and_b32 s41, s40, 3
    s_lshr_b32 s42, s40, 2
    s_lshl_b32 s42, s42, 13
    v_xor_b32 v7, s41, v5
    v_lshl_add_u32 v7, v7, 5, v6
    v_add_u32 v236, s42, v7
    v_mov_b32 v244, v236
    s_mul_i32 s40, s26, 4
    s_add_u32 s40, s40, 1
    s_and_b32 s41, s40, 3
    s_lshr_b32 s42, s40, 2
    s_lshl_b32 s42, s42, 13
    v_xor_b32 v7, s41, v5
    v_lshl_add_u32 v7, v7, 5, v6
    v_add_u32 v237, s42, v7
    v_mov_b32 v245, v237
    s_mul_i32 s40, s26, 4
    s_add_u32 s40, s40, 2
    s_and_b32 s41, s40, 3
    s_lshr_b32 s42, s40, 2
    s_lshl_b32 s42, s42, 13
    v_xor_b32 v7, s41, v5
    v_lshl_add_u32 v7, v7, 5, v6
    v_add_u32 v238, s42, v7
    v_mov_b32 v246, v238
    s_mul_i32 s40, s26, 4
    s_add_u32 s40, s40, 3
    s_and_b32 s41, s40, 3
    s_lshr_b32 s42, s40, 2
    s_lshl_b32 s42, s42, 13
    v_xor_b32 v7, s41, v5
    v_lshl_add_u32 v7, v7, 5, v6
    v_add_u32 v239, s42, v7
    v_mov_b32 v247, v239
    s_mov_b32 s32, 32768
    s_mov_b32 s33, 32768
    s_mov_b32 s34, 4294901760
    v_mov_b32 v16, 0
    v_mov_b32 v17, 0
    v_mov_b32 v18, 0
    v_mov_b32 v19, 0
    v_mov_b32 v20, 0
    v_mov_b32 v21, 0
    v_mov_b32 v22, 0
    v_mov_b32 v23, 0
    v_mov_b32 v24, 0
    v_mov_b32 v25, 0
    v_mov_b32 v26, 0
    v_mov_b32 v27, 0
    v_mov_b32 v28, 0
    v_mov_b32 v29, 0
    v_mov_b32 v30, 0
    v_mov_b32 v31, 0
    v_mov_b32 v32, 0
    v_mov_b32 v33, 0
    v_mov_b32 v34, 0
    v_mov_b32 v35, 0
    v_mov_b32 v36, 0
    v_mov_b32 v37, 0
    v_mov_b32 v38, 0
    v_mov_b32 v39, 0
    v_mov_b32 v40, 0
    v_mov_b32 v41, 0
    v_mov_b32 v42, 0
    v_mov_b32 v43, 0
    v_mov_b32 v44, 0
    v_mov_b32 v45, 0
    v_mov_b32 v46, 0
    v_mov_b32 v47, 0
    v_mov_b32 v48, 0
    v_mov_b32 v49, 0
    v_mov_b32 v50, 0
    v_mov_b32 v51, 0
    v_mov_b32 v52, 0
    v_mov_b32 v53, 0
    v_mov_b32 v54, 0
    v_mov_b32 v55, 0
    v_mov_b32 v56, 0
    v_mov_b32 v57, 0
    v_mov_b32 v58, 0
    v_mov_b32 v59, 0
    v_mov_b32 v60, 0
    v_mov_b32 v61, 0
    v_mov_b32 v62, 0
    v_mov_b32 v63, 0
    v_mov_b32 v64, 0
    v_mov_b32 v65, 0
    v_mov_b32 v66, 0
    v_mov_b32 v67, 0
    v_mov_b32 v68, 0
    v_mov_b32 v69, 0
    v_mov_b32 v70, 0
    v_mov_b32 v71, 0
    v_mov_b32 v72, 0
    v_mov_b32 v73, 0
    v_mov_b32 v74, 0
    v_mov_b32 v75, 0
    v_mov_b32 v76, 0
    v_mov_b32 v77, 0
    v_mov_b32 v78, 0
    v_mov_b32 v79, 0
    s_barrier
    ds_read_b128 v[128:131], v232 offset:0
    ds_read_b128 v[132:135], v232 offset:2048
    ds_read_b128 v[136:139], v232 offset:4096
    ds_read_b128 v[140:143], v232 offset:6144
    ds_read_b64_tr_b16 v[144:145], v236 offset:0
    ds_read_b64_tr_b16 v[146:147], v236 offset:512
    ds_read_b64_tr_b16 v[148:149], v237 offset:0
    ds_read_b64_tr_b16 v[150:151], v237 offset:512
    ds_read_b64_tr_b16 v[152:153], v238 offset:0
    ds_read_b64_tr_b16 v[154:155], v238 offset:512
    ds_read_b64_tr_b16 v[156:157], v239 offset:0
    ds_read_b64_tr_b16 v[158:159], v239 offset:512
    v_add_u32 v232, s32, v232
    v_add_u32 v236, s32, v236
    v_add_u32 v237, s32, v237
    v_add_u32 v238, s32, v238
    v_add_u32 v239, s32, v239
    s_mov_b32 s22, 27
L_gemm_w2_kernel_loop:
    s_waitcnt lgkmcnt(0)
    v_mfma_f32_16x16x32_bf16 v[16:19], v[144:147], v[128:131], v[16:19]
    ds_read_b128 v[176:179], v233 offset:0
    ds_read_b128 v[180:183], v233 offset:2048
    v_mfma_f32_16x16x32_bf16 v[32:35], v[144:147], v[132:135], v[32:35]
    ds_read_b128 v[184:187], v233 offset:4096
    v_mfma_f32_16x16x32_bf16 v[48:51], v[144:147], v[136:139], v[48:51]
    ds_read_b128 v[188:191], v233 offset:6144
    v_mfma_f32_16x16x32_bf16 v[64:67], v[144:147], v[140:143], v[64:67]
    ds_read_b64_tr_b16 v[192:193], v244 offset:4096
    v_mfma_f32_16x16x32_bf16 v[20:23], v[148:151], v[128:131], v[20:23]
    ds_read_b64_tr_b16 v[194:195], v244 offset:4608
    v_mfma_f32_16x16x32_bf16 v[36:39], v[148:151], v[132:135], v[36:39]
    ds_read_b64_tr_b16 v[196:197], v245 offset:4096
    v_mfma_f32_16x16x32_bf16 v[52:55], v[148:151], v[136:139], v[52:55]
    ds_read_b64_tr_b16 v[198:199], v245 offset:4608
    v_mfma_f32_16x16x32_bf16 v[68:71], v[148:151], v[140:143], v[68:71]
    ds_read_b64_tr_b16 v[200:201], v246 offset:4096
    v_mfma_f32_16x16x32_bf16 v[24:27], v[152:155], v[128:131], v[24:27]
    ds_read_b64_tr_b16 v[202:203], v246 offset:4608
    v_mfma_f32_16x16x32_bf16 v[40:43], v[152:155], v[132:135], v[40:43]
    ds_read_b64_tr_b16 v[204:205], v247 offset:4096
    v_mfma_f32_16x16x32_bf16 v[56:59], v[152:155], v[136:139], v[56:59]
    ds_read_b64_tr_b16 v[206:207], v247 offset:4608
    v_mfma_f32_16x16x32_bf16 v[72:75], v[152:155], v[140:143], v[72:75]
    v_add_u32 v233, s32, v233
    v_mfma_f32_16x16x32_bf16 v[28:31], v[156:159], v[128:131], v[28:31]
    v_add_u32 v244, s32, v244
    v_mfma_f32_16x16x32_bf16 v[44:47], v[156:159], v[132:135], v[44:47]
    v_add_u32 v245, s32, v245
    v_mfma_f32_16x16x32_bf16 v[60:63], v[156:159], v[136:139], v[60:63]
    v_add_u32 v246, s32, v246
    v_mfma_f32_16x16x32_bf16 v[76:79], v[156:159], v[140:143], v[76:79]
    v_add_u32 v247, s32, v247
    s_waitcnt lgkmcnt(0)
    s_barrier
    v_mfma_f32_16x16x32_bf16 v[16:19], v[192:195], v[176:179], v[16:19]
    ds_read_b128 v[128:131], v232 offset:0
    ds_read_b128 v[132:135], v232 offset:2048
    v_mfma_f32_16x16x32_bf16 v[32:35], v[192:195], v[180:183], v[32:35]
    ds_read_b128 v[136:139], v232 offset:4096
    ds_read_b128 v[140:143], v232 offset:6144
    v_mfma_f32_16x16x32_bf16 v[48:51], v[192:195], v[184:187], v[48:51]
    ds_read_b64_tr_b16 v[144:145], v236 offset:0
    ds_read_b64_tr_b16 v[146:147], v236 offset:512
    v_mfma_f32_16x16x32_bf16 v[64:67], v[192:195], v[188:191], v[64:67]
    ds_read_b64_tr_b16 v[148:149], v237 offset:0
    ds_read_b64_tr_b16 v[150:151], v237 offset:512
    v_mfma_f32_16x16x32_bf16 v[20:23], v[196:199], v[176:179], v[20:23]
    ds_read_b64_tr_b16 v[152:153], v238 offset:0
    ds_read_b64_tr_b16 v[154:155], v238 offset:512
    v_mfma_f32_16x16x32_bf16 v[36:39], v[196:199], v[180:183], v[36:39]
    ds_read_b64_tr_b16 v[156:157], v239 offset:0
    v_mfma_f32_16x16x32_bf16 v[52:55], v[196:199], v[184:187], v[52:55]
    ds_read_b64_tr_b16 v[158:159], v239 offset:512
    v_mfma_f32_16x16x32_bf16 v[68:71], v[196:199], v[188:191], v[68:71]
    v_add_u32 v232, s33, v232
    v_mfma_f32_16x16x32_bf16 v[24:27], v[200:203], v[176:179], v[24:27]
    v_add_u32 v236, s33, v236
    v_mfma_f32_16x16x32_bf16 v[40:43], v[200:203], v[180:183], v[40:43]
    v_add_u32 v237, s33, v237
    v_mfma_f32_16x16x32_bf16 v[56:59], v[200:203], v[184:187], v[56:59]
    v_add_u32 v238, s33, v238
    v_mfma_f32_16x16x32_bf16 v[72:75], v[200:203], v[188:191], v[72:75]
    v_add_u32 v239, s33, v239
    v_mfma_f32_16x16x32_bf16 v[28:31], v[204:207], v[176:179], v[28:31]
    s_mov_b32 s35, s32
    v_mfma_f32_16x16x32_bf16 v[44:47], v[204:207], v[180:183], v[44:47]
    s_mov_b32 s32, s33
    v_mfma_f32_16x16x32_bf16 v[60:63], v[204:207], v[184:187], v[60:63]
    s_mov_b32 s33, s34
    v_mfma_f32_16x16x32_bf16 v[76:79], v[204:207], v[188:191], v[76:79]
    s_mov_b32 s34, s35
    s_sub_u32 s22, s22, 1
    s_cmp_lg_u32 s22, 0
    s_cbranch_scc1 L_gemm_w2_kernel_loop
    s_waitcnt lgkmcnt(0)
    v_mfma_f32_16x16x32_bf16 v[16:19], v[144:147], v[128:131], v[16:19]
    ds_read_b128 v[176:179], v233 offset:0
    ds_read_b128 v[180:183], v233 offset:2048
    v_mfma_f32_16x16x32_bf16 v[32:35], v[144:147], v[132:135], v[32:35]
    ds_read_b128 v[184:187], v233 offset:4096
    v_mfma_f32_16x16x32_bf16 v[48:51], v[144:147], v[136:139], v[48:51]
    ds_read_b128 v[188:191], v233 offset:6144
    v_mfma_f32_16x16x32_bf16 v[64:67], v[144:147], v[140:143], v[64:67]
    ds_read_b64_tr_b16 v[192:193], v244 offset:4096
    v_mfma_f32_16x16x32_bf16 v[20:23], v[148:151], v[128:131], v[20:23]
    ds_read_b64_tr_b16 v[194:195], v244 offset:4608
    v_mfma_f32_16x16x32_bf16 v[36:39], v[148:151], v[132:135], v[36:39]
    ds_read_b64_tr_b16 v[196:197], v245 offset:4096
    v_mfma_f32_16x16x32_bf16 v[52:55], v[148:151], v[136:139], v[52:55]
    ds_read_b64_tr_b16 v[198:199], v245 offset:4608
    v_mfma_f32_16x16x32_bf16 v[68:71], v[148:151], v[140:143], v[68:71]
    ds_read_b64_tr_b16 v[200:201], v246 offset:4096
    v_mfma_f32_16x16x32_bf16 v[24:27], v[152:155], v[128:131], v[24:27]
    ds_read_b64_tr_b16 v[202:203], v246 offset:4608
    v_mfma_f32_16x16x32_bf16 v[40:43], v[152:155], v[132:135], v[40:43]
    ds_read_b64_tr_b16 v[204:205], v247 offset:4096
    v_mfma_f32_16x16x32_bf16 v[56:59], v[152:155], v[136:139], v[56:59]
    ds_read_b64_tr_b16 v[206:207], v247 offset:4608
    v_mfma_f32_16x16x32_bf16 v[72:75], v[152:155], v[140:143], v[72:75]
    v_add_u32 v233, s32, v233
    v_mfma_f32_16x16x32_bf16 v[28:31], v[156:159], v[128:131], v[28:31]
    v_add_u32 v244, s32, v244
    v_mfma_f32_16x16x32_bf16 v[44:47], v[156:159], v[132:135], v[44:47]
    v_add_u32 v245, s32, v245
    v_mfma_f32_16x16x32_bf16 v[60:63], v[156:159], v[136:139], v[60:63]
    v_add_u32 v246, s32, v246
    v_mfma_f32_16x16x32_bf16 v[76:79], v[156:159], v[140:143], v[76:79]
    v_add_u32 v247, s32, v247
    s_waitcnt lgkmcnt(0)
    v_mfma_f32_16x16x32_bf16 v[16:19], v[192:195], v[176:179], v[16:19]
    s_mov_b32 s35, s32
    v_mfma_f32_16x16x32_bf16 v[32:35], v[192:195], v[180:183], v[32:35]
    s_mov_b32 s32, s33
    v_mfma_f32_16x16x32_bf16 v[48:51], v[192:195], v[184:187], v[48:51]
    s_mov_b32 s33, s34
    v_mfma_f32_16x16x32_bf16 v[64:67], v[192:195], v[188:191], v[64:67]
    s_mov_b32 s34, s35
    v_mfma_f32_16x16x32_bf16 v[20:23], v[196:199], v[176:179], v[20:23]
    v_mfma_f32_16x16x32_bf16 v[36:39], v[196:199], v[180:183], v[36:39]
    v_mfma_f32_16x16x32_bf16 v[52:55], v[196:199], v[184:187], v[52:55]
    v_mfma_f32_16x16x32_bf16 v[68:71], v[196:199], v[188:191], v[68:71]
    v_mfma_f32_16x16x32_bf16 v[24:27], v[200:203], v[176:179], v[24:27]
    v_mfma_f32_16x16x32_bf16 v[40:43], v[200:203], v[180:183], v[40:43]
    v_mfma_f32_16x16x32_bf16 v[56:59], v[200:203], v[184:187], v[56:59]
    v_mfma_f32_16x16x32_bf16 v[72:75], v[200:203], v[188:191], v[72:75]
    v_mfma_f32_16x16x32_bf16 v[28:31], v[204:207], v[176:179], v[28:31]
    v_mfma_f32_16x16x32_bf16 v[44:47], v[204:207], v[180:183], v[44:47]
    v_mfma_f32_16x16x32_bf16 v[60:63], v[204:207], v[184:187], v[60:63]
    v_mfma_f32_16x16x32_bf16 v[76:79], v[204:207], v[188:191], v[76:79]
    s_nop 7
    s_nop 7
    v_and_b32 v1, 63, v0
    v_and_b32 v2, 15, v1
    v_lshrrev_b32 v4, 4, v1
    s_lshl_b32 s40, s27, 7
    s_lshl_b32 s41, s25, 6
    s_add_u32 s40, s40, s41
    v_add_u32 v3, s40, v2
    s_add_u32 s16, s4, 33554432
    s_addc_u32 s17, s5, 0
    s_mov_b32 s18, 16777216
    s_mov_b32 s19, 0x00020000
    s_lshl_b32 s40, s28, 9
    s_lshl_b32 s41, s26, 8
    s_add_u32 s40, s40, s41
    s_mul_i32 s41, s29, 8388608
    s_add_u32 s40, s40, s41
    v_lshl_add_u32 v5, v4, 4, s40
    v_lshl_add_u32 v6, v3, 12, v5
    s_mov_b32 s44, 65536
    s_mov_b32 s45, 131072
    s_mov_b32 s46, 196608
    s_barrier
    s_mul_i32 s58, s24, 17408
    v_mul_u32_u24 v7, 272, v2
    v_lshl_add_u32 v7, v4, 4, v7
    v_add_u32 v7, s58, v7
    ds_write_b128 v7, v[16:19] offset:0
    ds_write_b128 v7, v[20:23] offset:64
    ds_write_b128 v7, v[24:27] offset:128
    ds_write_b128 v7, v[28:31] offset:192
    ds_write_b128 v7, v[32:35] offset:4352
    ds_write_b128 v7, v[36:39] offset:4416
    ds_write_b128 v7, v[40:43] offset:4480
    ds_write_b128 v7, v[44:47] offset:4544
    ds_write_b128 v7, v[48:51] offset:8704
    ds_write_b128 v7, v[52:55] offset:8768
    ds_write_b128 v7, v[56:59] offset:8832
    ds_write_b128 v7, v[60:63] offset:8896
    ds_write_b128 v7, v[64:67] offset:13056
    ds_write_b128 v7, v[68:71] offset:13120
    ds_write_b128 v7, v[72:75] offset:13184
    ds_write_b128 v7, v[76:79] offset:13248
    s_waitcnt lgkmcnt(0)
    v_lshrrev_b32 v8, 4, v1
    v_and_b32 v9, 15, v1
    v_mul_u32_u24 v10, 272, v8
    v_lshl_add_u32 v10, v9, 4, v10
    v_add_u32 v10, s58, v10
    s_lshl_b32 s41, s27, 7
    s_lshl_b32 s42, s25, 6
    s_add_u32 s41, s41, s42
    v_add_u32 v8, s41, v8
    v_lshlrev_b32 v8, 12, v8
    v_lshl_add_u32 v8, v9, 4, v8
    v_add_u32 v8, s40, v8
    ds_read_b128 v[128:131], v10 offset:0
    ds_read_b128 v[132:135], v10 offset:1088
    ds_read_b128 v[136:139], v10 offset:2176
    ds_read_b128 v[140:143], v10 offset:3264
    ds_read_b128 v[144:147], v10 offset:4352
    ds_read_b128 v[148:151], v10 offset:5440
    ds_read_b128 v[152:155], v10 offset:6528
    ds_read_b128 v[156:159], v10 offset:7616
    ds_read_b128 v[160:163], v10 offset:8704
    ds_read_b128 v[164:167], v10 offset:9792
    ds_read_b128 v[168:171], v10 offset:10880
    ds_read_b128 v[172:175], v10 offset:11968
    ds_read_b128 v[176:179], v10 offset:13056
    ds_read_b128 v[180:183], v10 offset:14144
    ds_read_b128 v[184:187], v10 offset:15232
    ds_read_b128 v[188:191], v10 offset:16320
    s_mov_b32 s41, 0
    s_waitcnt lgkmcnt(15)
    buffer_store_dwordx4 v[128:131], v8, s[16:19], s41 offen
    s_mov_b32 s41, 16384
    s_waitcnt lgkmcnt(14)
    buffer_store_dwordx4 v[132:135], v8, s[16:19], s41 offen
    s_mov_b32 s41, 32768
    s_waitcnt lgkmcnt(13)
    buffer_store_dwordx4 v[136:139], v8, s[16:19], s41 offen
    s_mov_b32 s41, 49152
    s_waitcnt lgkmcnt(12)
    buffer_store_dwordx4 v[140:143], v8, s[16:19], s41 offen
    s_mov_b32 s41, 65536
    s_waitcnt lgkmcnt(11)
    buffer_store_dwordx4 v[144:147], v8, s[16:19], s41 offen
    s_mov_b32 s41, 81920
    s_waitcnt lgkmcnt(10)
    buffer_store_dwordx4 v[148:151], v8, s[16:19], s41 offen
    s_mov_b32 s41, 98304
    s_waitcnt lgkmcnt(9)
    buffer_store_dwordx4 v[152:155], v8, s[16:19], s41 offen
    s_mov_b32 s41, 114688
    s_waitcnt lgkmcnt(8)
    buffer_store_dwordx4 v[156:159], v8, s[16:19], s41 offen
    s_mov_b32 s41, 131072
    s_waitcnt lgkmcnt(7)
    buffer_store_dwordx4 v[160:163], v8, s[16:19], s41 offen
    s_mov_b32 s41, 147456
    s_waitcnt lgkmcnt(6)
    buffer_store_dwordx4 v[164:167], v8, s[16:19], s41 offen
    s_mov_b32 s41, 163840
    s_waitcnt lgkmcnt(5)
    buffer_store_dwordx4 v[168:171], v8, s[16:19], s41 offen
    s_mov_b32 s41, 180224
    s_waitcnt lgkmcnt(4)
    buffer_store_dwordx4 v[172:175], v8, s[16:19], s41 offen
    s_mov_b32 s41, 196608
    s_waitcnt lgkmcnt(3)
    buffer_store_dwordx4 v[176:179], v8, s[16:19], s41 offen
    s_mov_b32 s41, 212992
    s_waitcnt lgkmcnt(2)
    buffer_store_dwordx4 v[180:183], v8, s[16:19], s41 offen
    s_mov_b32 s41, 229376
    s_waitcnt lgkmcnt(1)
    buffer_store_dwordx4 v[184:187], v8, s[16:19], s41 offen
    s_mov_b32 s41, 245760
    s_waitcnt lgkmcnt(0)
    buffer_store_dwordx4 v[188:191], v8, s[16:19], s41 offen
L_gemm_w2_kernel_end:
    s_endpgm
.section .rodata,"a"
.p2align 6
.amdhsa_kernel ln_in_kernel
  .amdhsa_next_free_vgpr 96
  .amdhsa_next_free_sgpr 102
  .amdhsa_accum_offset 96
  .amdhsa_group_segment_fixed_size 0
  .amdhsa_kernarg_size 88
  .amdhsa_user_sgpr_count 2
  .amdhsa_user_sgpr_kernarg_segment_ptr 1
  .amdhsa_system_sgpr_workgroup_id_x 1
.end_amdhsa_kernel
.amdhsa_kernel ln_two_kernel
  .amdhsa_next_free_vgpr 96
  .amdhsa_next_free_sgpr 102
  .amdhsa_accum_offset 96
  .amdhsa_group_segment_fixed_size 0
  .amdhsa_kernarg_size 88
  .amdhsa_user_sgpr_count 2
  .amdhsa_user_sgpr_kernarg_segment_ptr 1
  .amdhsa_system_sgpr_workgroup_id_x 1
.end_amdhsa_kernel
.amdhsa_kernel ln_red_kernel
  .amdhsa_next_free_vgpr 96
  .amdhsa_next_free_sgpr 102
  .amdhsa_accum_offset 96
  .amdhsa_group_segment_fixed_size 0
  .amdhsa_kernarg_size 88
  .amdhsa_user_sgpr_count 2
  .amdhsa_user_sgpr_kernarg_segment_ptr 1
  .amdhsa_system_sgpr_workgroup_id_x 1
.end_amdhsa_kernel
.amdhsa_kernel ln_out_kernel
  .amdhsa_next_free_vgpr 96
  .amdhsa_next_free_sgpr 102
  .amdhsa_accum_offset 96
  .amdhsa_group_segment_fixed_size 0
  .amdhsa_kernarg_size 88
  .amdhsa_user_sgpr_count 2
  .amdhsa_user_sgpr_kernarg_segment_ptr 1
  .amdhsa_system_sgpr_workgroup_id_x 1
.end_amdhsa_kernel
.amdhsa_kernel attn_o_kernel
  .amdhsa_next_free_vgpr 128
  .amdhsa_next_free_sgpr 102
  .amdhsa_accum_offset 128
  .amdhsa_group_segment_fixed_size 0
  .amdhsa_kernarg_size 88
  .amdhsa_user_sgpr_count 2
  .amdhsa_user_sgpr_kernarg_segment_ptr 1
  .amdhsa_system_sgpr_workgroup_id_x 1
.end_amdhsa_kernel
.amdhsa_kernel gemm_qkv_kernel
  .amdhsa_next_free_vgpr 256
  .amdhsa_next_free_sgpr 102
  .amdhsa_accum_offset 256
  .amdhsa_group_segment_fixed_size 0
  .amdhsa_kernarg_size 88
  .amdhsa_user_sgpr_count 2
  .amdhsa_user_sgpr_kernarg_segment_ptr 1
  .amdhsa_system_sgpr_workgroup_id_x 1
.end_amdhsa_kernel
.amdhsa_kernel gemm_wo_kernel
  .amdhsa_next_free_vgpr 256
  .amdhsa_next_free_sgpr 102
  .amdhsa_accum_offset 256
  .amdhsa_group_segment_fixed_size 0
  .amdhsa_kernarg_size 88
  .amdhsa_user_sgpr_count 2
  .amdhsa_user_sgpr_kernarg_segment_ptr 1
  .amdhsa_system_sgpr_workgroup_id_x 1
.end_amdhsa_kernel
.amdhsa_kernel gemm_w1_kernel
  .amdhsa_next_free_vgpr 256
  .amdhsa_next_free_sgpr 102
  .amdhsa_accum_offset 256
  .amdhsa_group_segment_fixed_size 0
  .amdhsa_kernarg_size 88
  .amdhsa_user_sgpr_count 2
  .amdhsa_user_sgpr_kernarg_segment_ptr 1
  .amdhsa_system_sgpr_workgroup_id_x 1
.end_amdhsa_kernel
.amdhsa_kernel gemm_w2_kernel
  .amdhsa_next_free_vgpr 256
  .amdhsa_next_free_sgpr 102
  .amdhsa_accum_offset 256
  .amdhsa_group_segment_fixed_size 0
  .amdhsa_kernarg_size 88
  .amdhsa_user_sgpr_count 2
  .amdhsa_user_sgpr_kernarg_segment_ptr 1
  .amdhsa_system_sgpr_workgroup_id_x 1
.end_amdhsa_kernel
```
